```python
import torch

def _softmax(x, axis=-1):
    return torch.softmax(x, dim=axis)
def _gelu(x):
    return torch.nn.functional.gelu(x, approximate="tanh")
def _silu(x):
    return torch.nn.functional.silu(x)
def _sigmoid(x):
    return torch.sigmoid(x)
def _layernorm(x, axis=-1, eps=1e-5):
    m = x.mean(dim=axis, keepdim=True)
    v = x.var(dim=axis, keepdim=True, unbiased=False)
    return (x - m) / torch.sqrt(v + eps)
def _scatter_add(tgt, idx, src, axis=0):
    return tgt.clone().index_add_(axis, idx, src)
def _segment_sum(src, seg, n):
    out = torch.zeros((n,) + src.shape[1:], dtype=src.dtype)
    return out.index_add_(0, seg, src)
def _pad(x, pw):
    flat = tuple(v for pair in reversed(pw) for v in pair)
    return torch.nn.functional.pad(x, flat)

kernel_name = 'standalone__gqa_block_cached__near_ridge'

def setup_inputs():

    _w = (lambda a: (lambda t: t.to(torch.bfloat16) if t.is_floating_point() else t)(torch.as_tensor(a)))
    B, Sq, D = 16, 64, 640
    Hq, Hkv, Sk, Dh = 32, 32, 64, 128
    assert Hq % Hkv == 0, (Hq, Hkv)
    return {
        "x": _w((lambda *s: torch.randn(*s, dtype=torch.bfloat16) * 0.8)(B, Sq, D)),
        "k_cache": _w((lambda *s: torch.randn(*s, dtype=torch.bfloat16) * 0.8)(B, Hkv, Sk, Dh)),
        "v_cache": _w((lambda *s: torch.randn(*s, dtype=torch.bfloat16) * 0.05)(B, Hkv, Sk, Dh)),
        "wq": _w((lambda *s: torch.randn(*s, dtype=torch.bfloat16) * 0.8)(D, Hq * Dh) * (D ** -0.5)),
        "wo": _w((lambda *s: torch.randn(*s, dtype=torch.bfloat16) * 0.05)(Hq * Dh, D) * ((Hq * Dh) ** -0.5)),
    }

def reference(x, k_cache, v_cache, wq, wo):
    B, Sq, D = x.shape
    Hq, Dh = 32, 128
    Hkv = k_cache.shape[1]
    rep = Hq // Hkv
    q = (lambda x, *d: x.permute(*d))((x @ wq).reshape(B, Sq, Hq, Dh), 0, 2, 1, 3)
    k = (lambda x, n, axis: torch.repeat_interleave(x, n, dim=axis))(k_cache, rep, axis=1)
    v = (lambda x, n, axis: torch.repeat_interleave(x, n, dim=axis))(v_cache, rep, axis=1)
    scores = torch.einsum("bhqd,bhkd->bhqk", q, k) * (Dh ** -0.5)
    p = _softmax(scores, axis=-1)
    o = torch.einsum("bhqk,bhkd->bhqd", p, v)
    return (lambda x, *d: x.permute(*d))(o, 0, 2, 1, 3).reshape(B, Sq, Hq * Dh) @ wo
```

```asm
; @launch grid=(256,1,1) block=(256,1,1) lds=163840
.amdgcn_target "amdgcn-amd-amdhsa--gfx950"
.text
.globl standalone__gqa_block_cached__near_ridge_kernel
.p2align 8
.type standalone__gqa_block_cached__near_ridge_kernel,@function
standalone__gqa_block_cached__near_ridge_kernel:
    s_cmp_ge_u32 s2, 256
    s_cbranch_scc1 L_end
    s_load_dwordx2 s[8:9], s[0:1], 0
    s_load_dwordx2 s[12:13], s[0:1], 24
    s_load_dwordx2 s[32:33], s[0:1], 56
    s_load_dwordx2 s[16:17], s[0:1], 8
    s_load_dwordx2 s[20:21], s[0:1], 16
    s_load_dwordx2 s[24:25], s[0:1], 32
    s_load_dwordx2 s[28:29], s[0:1], 40
    v_and_b32 v1, 63, v0
    v_lshrrev_b32 v2, 6, v0
    s_and_b32 s37, s2, 7
    s_lshr_b32 s41, s2, 3
    v_readfirstlane_b32 s36, v2
    s_lshr_b32 s38, s41, 2
    s_and_b32 s39, s41, 3
    s_lshl_b32 s40, s37, 2
    s_add_u32 s40, s40, s39
    s_mov_b32 s10, 0x140000
    s_mov_b32 s11, 0x20000
    s_mov_b32 s18, 0x800000
    s_mov_b32 s19, 0x20000
    s_mov_b32 s22, 0x800000
    s_mov_b32 s23, 0x20000
    s_mov_b32 s14, 0x500000
    s_mov_b32 s15, 0x20000
    s_mov_b32 s26, 0x500000
    s_mov_b32 s27, 0x20000
    s_mov_b32 s30, 0x140000
    s_mov_b32 s31, 0x20000
    s_mov_b32 s34, 0x10000000
    s_mov_b32 s35, 0x20000
    v_lshrrev_b32 v2, 4, v1
    v_and_b32 v3, 15, v1
    v_lshlrev_b32 v4, 2, v2
    v_xor_b32 v4, v3, v4
    v_lshlrev_b32 v4, 4, v4
    v_lshl_add_u32 v16, v2, 13, v4
    v_lshl_add_u32 v28, v2, 8, v4
    v_add_u32 v17, 31744, v16
    v_add_u32 v18, 63488, v16
    v_add_u32 v19, 95232, v16
    v_xor_b32 v4, v3, v2
    v_lshlrev_b32 v4, 4, v4
    v_lshl_add_u32 v24, v2, 8, v4
    v_lshrrev_b32 v5, 3, v1
    v_and_b32 v6, 7, v1
    v_lshrrev_b32 v7, 1, v5
    v_xor_b32 v7, v6, v7
    v_lshlrev_b32 v7, 4, v7
    v_mul_u32_u24 v5, 1280, v5
    v_add_u32 v20, v5, v7
    v_xor_b32 v7, 64, v7
    v_add_u32 v8, v5, v7
    v_add_u32 v21, 9216, v8
    v_add_u32 v22, 18432, v20
    v_add_u32 v23, 27648, v8
    v_xor_b32 v25, 64, v24
    v_xor_b32 v26, 128, v24
    v_xor_b32 v27, 192, v24
    v_lshlrev_b32 v30, 4, v1
    s_lshl_b32 s45, s36, 17
    s_lshl_b32 s41, s40, 8
    s_add_u32 s45, s45, s41
    s_lshl_b32 s41, s38, 2
    s_add_u32 s41, s41, s36
    s_mul_i32 s46, s41, 40960
    s_lshl_b32 s48, s36, 12
    s_lshl_b32 s50, s36, 13
    s_lshr_b32 s51, s39, 1
    s_mul_i32 s51, s51, 3
    s_lshr_b32 s41, s38, 1
    s_mul_i32 s41, s41, 1
    s_add_u32 s51, s51, s41
    s_cmp_ge_u32 s51, 10
    s_cselect_b32 s41, 10, 0
    s_sub_u32 s51, s51, s41
    s_cmp_ge_u32 s51, 10
    s_cselect_b32 s41, 10, 0
    s_sub_u32 s51, s51, s41
    s_cmp_ge_u32 s51, 10
    s_cselect_b32 s41, 10, 0
    s_sub_u32 s51, s51, s41
    s_lshl_b32 s41, s38, 3
    s_add_u32 s41, s41, s37
    s_lshl_b32 s41, s41, 7
    s_add_u32 s41, s41, 0x2000000
    s_lshl_b32 s42, s38, 2
    s_add_u32 s42, s42, s39
    s_lshl_b32 s42, s42, 7
    s_add_u32 s42, s42, 0x2002000
    v_mov_b32 v2, s41
    v_mov_b32 v3, s42
    v_cmp_eq_u32 vcc, 1, v1
    s_nop 1
    v_cndmask_b32 v52, v2, v3, vcc
    s_waitcnt lgkmcnt(0)
    s_add_u32 m0, s48, 0
    s_lshl_b32 s49, s51, 19
    s_add_u32 s49, s49, s45
    buffer_load_dwordx4 v16, s[12:15], s49 offen offset:0 lds
    buffer_load_dwordx4 v17, s[12:15], s49 offen offset:1024 lds
    buffer_load_dwordx4 v18, s[12:15], s49 offen offset:2048 lds
    buffer_load_dwordx4 v19, s[12:15], s49 offen offset:3072 lds
    s_add_u32 m0, s48, 16384
    s_lshl_b32 s49, s51, 7
    s_add_u32 s49, s49, s46
    buffer_load_dwordx4 v20, s[8:11], s49 offen offset:0 lds
    buffer_load_dwordx4 v21, s[8:11], s49 offen offset:1024 lds
    buffer_load_dwordx4 v22, s[8:11], s49 offen offset:2048 lds
    buffer_load_dwordx4 v23, s[8:11], s49 offen offset:3072 lds
    s_add_u32 s51, s51, 1
    s_cmp_eq_u32 s51, 10
    s_cselect_b32 s51, 0, s51
    s_add_u32 m0, s48, 32768
    s_lshl_b32 s49, s51, 19
    s_add_u32 s49, s49, s45
    buffer_load_dwordx4 v16, s[12:15], s49 offen offset:0 lds
    buffer_load_dwordx4 v17, s[12:15], s49 offen offset:1024 lds
    buffer_load_dwordx4 v18, s[12:15], s49 offen offset:2048 lds
    buffer_load_dwordx4 v19, s[12:15], s49 offen offset:3072 lds
    s_add_u32 m0, s48, 49152
    s_lshl_b32 s49, s51, 7
    s_add_u32 s49, s49, s46
    buffer_load_dwordx4 v20, s[8:11], s49 offen offset:0 lds
    buffer_load_dwordx4 v21, s[8:11], s49 offen offset:1024 lds
    buffer_load_dwordx4 v22, s[8:11], s49 offen offset:2048 lds
    buffer_load_dwordx4 v23, s[8:11], s49 offen offset:3072 lds
    s_add_u32 s51, s51, 1
    s_cmp_eq_u32 s51, 10
    s_cselect_b32 s51, 0, s51
    buffer_load_dword v29, v52, s[32:35], 0 offen sc1
    v_lshrrev_b32 v2, 5, v1
    v_and_b32 v3, 31, v1
    v_bfe_u32 v4, v1, 4, 1
    v_bfe_u32 v5, v1, 2, 2
    v_and_b32 v6, 3, v1
    v_lshl_add_u32 v7, v2, 3, v5
    v_lshlrev_b32 v7, 8, v7
    v_lshl_add_u32 v7, v4, 5, v7
    v_and_b32 v8, 1, v6
    v_lshl_add_u32 v7, v8, 4, v7
    v_lshrrev_b32 v8, 1, v6
    v_lshl_add_u32 v7, v8, 3, v7
    v_lshl_add_u32 v200, v5, 6, v7
    v_xor_b32 v201, 64, v200
    v_xor_b32 v202, 128, v200
    v_xor_b32 v203, 192, v200
    v_bfe_u32 v7, v3, 1, 3
    v_xor_b32 v7, v7, v2
    v_lshlrev_b32 v7, 4, v7
    v_lshl_add_u32 v7, v3, 7, v7
    s_add_u32 s42, s48, 16384
    v_add_u32 v204, s42, v7
    v_xor_b32 v205, 32, v204
    v_xor_b32 v206, 64, v204
    v_xor_b32 v207, 96, v204
    v_add_u32 v208, 0x10000, v200
    v_add_u32 v209, 0x10000, v201
    v_add_u32 v210, 0x10000, v202
    v_add_u32 v211, 0x10000, v203
    v_add_u32 v212, 0x10000, v204
    v_add_u32 v213, 0x10000, v205
    v_add_u32 v214, 0x10000, v206
    v_add_u32 v215, 0x10000, v207
    v_add_u32 v216, 0x20000, v200
    v_add_u32 v217, 0x20000, v201
    v_add_u32 v218, 0x20000, v202
    v_add_u32 v219, 0x20000, v203
    v_add_u32 v220, 0x20000, v204
    v_add_u32 v221, 0x20000, v205
    v_add_u32 v222, 0x20000, v206
    v_add_u32 v223, 0x20000, v207
    s_lshr_b32 s41, s36, 1
    s_lshl_b32 s41, s41, 14
    v_lshl_add_u32 v7, v2, 2, v5
    v_lshlrev_b32 v8, 8, v7
    v_lshl_add_u32 v8, v4, 5, v8
    v_lshl_add_u32 v8, v6, 3, v8
    v_lshl_add_u32 v8, v5, 6, v8
    s_add_u32 s42, s41, 32768
    v_add_u32 v40, s42, v8
    v_xor_b32 v41, 64, v40
    v_xor_b32 v42, 128, v40
    v_xor_b32 v43, 192, v40
    v_mul_u32_u24 v7, 320, v7
    v_lshl_add_u32 v7, v4, 5, v7
    v_lshl_add_u32 v49, v6, 3, v7
    v_add_u32 v50, 66560, v49
    v_add_u32 v51, 128000, v49
    v_and_b32 v7, 15, v3
    v_xor_b32 v7, v7, v2
    v_lshlrev_b32 v7, 4, v7
    v_lshl_add_u32 v7, v3, 8, v7
    v_add_u32 v32, s41, v7
    v_xor_b32 v33, 32, v32
    v_xor_b32 v34, 64, v32
    v_xor_b32 v35, 96, v32
    v_xor_b32 v36, 128, v32
    v_xor_b32 v37, 160, v32
    v_xor_b32 v38, 192, v32
    v_xor_b32 v39, 224, v32
    v_add_u32 v2, 0, v1
    v_mul_u32_u24 v3, 3277, v2
    v_lshrrev_b32 v3, 16, v3
    v_mul_u32_u24 v4, 20, v3
    v_sub_u32 v4, v2, v4
    v_mul_u32_u24 v3, 1280, v3
    v_lshl_add_u32 v44, v4, 4, v3
    v_add_u32 v2, 64, v1
    v_mul_u32_u24 v3, 3277, v2
    v_lshrrev_b32 v3, 16, v3
    v_mul_u32_u24 v4, 20, v3
    v_sub_u32 v4, v2, v4
    v_mul_u32_u24 v3, 1280, v3
    v_lshl_add_u32 v45, v4, 4, v3
    v_subrev_u32 v45, 1024, v45
    v_add_u32 v2, 128, v1
    v_mul_u32_u24 v3, 3277, v2
    v_lshrrev_b32 v3, 16, v3
    v_mul_u32_u24 v4, 20, v3
    v_sub_u32 v4, v2, v4
    v_mul_u32_u24 v3, 1280, v3
    v_lshl_add_u32 v46, v4, 4, v3
    v_subrev_u32 v46, 2048, v46
    v_add_u32 v2, 192, v1
    v_mul_u32_u24 v3, 3277, v2
    v_lshrrev_b32 v3, 16, v3
    v_mul_u32_u24 v4, 20, v3
    v_sub_u32 v4, v2, v4
    v_mul_u32_u24 v3, 1280, v3
    v_lshl_add_u32 v47, v4, 4, v3
    v_subrev_u32 v47, 3072, v47
    v_add_u32 v2, 256, v1
    v_mul_u32_u24 v3, 3277, v2
    v_lshrrev_b32 v3, 16, v3
    v_mul_u32_u24 v4, 20, v3
    v_sub_u32 v4, v2, v4
    v_mul_u32_u24 v3, 1280, v3
    v_lshl_add_u32 v48, v4, 4, v3
    s_lshr_b32 s41, s36, 1
    s_lshl_b32 s42, s38, 1
    s_add_u32 s41, s41, s42
    s_lshl_b32 s41, s41, 5
    s_add_u32 s41, s41, s40
    s_lshl_b32 s47, s41, 14
    s_and_b32 s41, s36, 1
    s_lshl_b32 s41, s41, 13
    s_add_u32 s47, s47, s41
    s_mul_i32 s43, s39, 320
    s_mul_i32 s44, s36, 20480
    s_add_u32 s43, s43, s44
    s_mul_i32 s44, s37, 655360
    s_add_u32 s43, s43, s44
    s_add_u32 s41, s39, 0
    s_and_b32 s41, s41, 3
    s_mul_i32 s41, s41, 163840
    s_add_u32 s52, s41, s43
    s_add_u32 s41, s39, 1
    s_and_b32 s41, s41, 3
    s_mul_i32 s41, s41, 163840
    s_add_u32 s53, s41, s43
    s_add_u32 s41, s39, 2
    s_and_b32 s41, s41, 3
    s_mul_i32 s41, s41, 163840
    s_add_u32 s54, s41, s43
    s_add_u32 s41, s39, 3
    s_and_b32 s41, s41, 3
    s_mul_i32 s41, s41, 163840
    s_add_u32 s55, s41, s43
    v_lshlrev_b32 v62, 7, v1
    v_min_u32 v63, 39, v1
    v_lshlrev_b32 v63, 7, v63
    s_lshr_b32 s41, s2, 3
    s_lshl_b32 s41, s41, 2
    s_add_u32 s41, s41, s36
    s_lshl_b32 s41, s41, 2
    s_lshl_b32 s42, s37, 9
    s_add_u32 s41, s41, s42
    s_mul_i32 s96, s41, 1280
    s_lshl_b32 s41, s38, 3
    s_add_u32 s41, s41, s37
    s_lshl_b32 s41, s41, 2
    s_add_u32 s41, s41, s36
    s_lshl_b32 s58, s41, 15
    s_add_u32 m0, s48, 65536
    s_lshl_b32 s49, s51, 19
    s_add_u32 s49, s49, s45
    buffer_load_dwordx4 v16, s[12:15], s49 offen offset:0 lds
    buffer_load_dwordx4 v17, s[12:15], s49 offen offset:1024 lds
    buffer_load_dwordx4 v18, s[12:15], s49 offen offset:2048 lds
    buffer_load_dwordx4 v19, s[12:15], s49 offen offset:3072 lds
    s_add_u32 m0, s48, 81920
    s_lshl_b32 s49, s51, 7
    s_add_u32 s49, s49, s46
    buffer_load_dwordx4 v20, s[8:11], s49 offen offset:0 lds
    buffer_load_dwordx4 v21, s[8:11], s49 offen offset:1024 lds
    buffer_load_dwordx4 v22, s[8:11], s49 offen offset:2048 lds
    buffer_load_dwordx4 v23, s[8:11], s49 offen offset:3072 lds
    s_add_u32 s51, s51, 1
    s_cmp_eq_u32 s51, 10
    s_cselect_b32 s51, 0, s51
    s_waitcnt vmcnt(17)
    s_barrier
    ds_read_b128 v[160:163], v204 offset:0
    ds_read_b64_tr_b16 v[128:129], v200 offset:0
    ds_read_b64_tr_b16 v[130:131], v200 offset:1024
    ds_read_b64_tr_b16 v[132:133], v201 offset:0
    ds_read_b64_tr_b16 v[134:135], v201 offset:1024
    ds_read_b64_tr_b16 v[136:137], v202 offset:0
    ds_read_b64_tr_b16 v[138:139], v202 offset:1024
    ds_read_b64_tr_b16 v[140:141], v203 offset:0
    ds_read_b64_tr_b16 v[142:143], v203 offset:1024
    s_waitcnt lgkmcnt(6)
    v_mfma_f32_32x32x16_bf16 v[64:79], v[128:131], v[160:163], 0
    ds_read_b128 v[164:167], v205 offset:0
    ds_read_b64_tr_b16 v[144:145], v200 offset:4096
    ds_read_b64_tr_b16 v[146:147], v200 offset:5120
    s_waitcnt lgkmcnt(7)
    v_mfma_f32_32x32x16_bf16 v[80:95], v[132:135], v[160:163], 0
    ds_read_b64_tr_b16 v[148:149], v201 offset:4096
    ds_read_b64_tr_b16 v[150:151], v201 offset:5120
    ds_read_b64_tr_b16 v[152:153], v202 offset:4096
    s_add_u32 m0, s48, 98304
    s_lshl_b32 s49, s51, 19
    s_add_u32 s49, s49, s45
    buffer_load_dwordx4 v16, s[12:15], s49 offen offset:0 lds
    s_waitcnt lgkmcnt(8)
    v_mfma_f32_32x32x16_bf16 v[96:111], v[136:139], v[160:163], 0
    ds_read_b64_tr_b16 v[154:155], v202 offset:5120
    ds_read_b64_tr_b16 v[156:157], v203 offset:4096
    ds_read_b64_tr_b16 v[158:159], v203 offset:5120
    buffer_load_dwordx4 v17, s[12:15], s49 offen offset:1024 lds
    s_waitcnt lgkmcnt(9)
    v_mfma_f32_32x32x16_bf16 v[112:127], v[140:143], v[160:163], 0
    buffer_load_dwordx4 v18, s[12:15], s49 offen offset:2048 lds
    s_waitcnt lgkmcnt(6)
    v_mfma_f32_32x32x16_bf16 v[64:79], v[144:147], v[164:167], v[64:79]
    ds_read_b128 v[160:163], v206 offset:0
    ds_read_b64_tr_b16 v[128:129], v200 offset:8192
    ds_read_b64_tr_b16 v[130:131], v200 offset:9216
    s_waitcnt lgkmcnt(7)
    v_mfma_f32_32x32x16_bf16 v[80:95], v[148:151], v[164:167], v[80:95]
    ds_read_b64_tr_b16 v[132:133], v201 offset:8192
    ds_read_b64_tr_b16 v[134:135], v201 offset:9216
    ds_read_b64_tr_b16 v[136:137], v202 offset:8192
    buffer_load_dwordx4 v19, s[12:15], s49 offen offset:3072 lds
    s_waitcnt lgkmcnt(8)
    v_mfma_f32_32x32x16_bf16 v[96:111], v[152:155], v[164:167], v[96:111]
    ds_read_b64_tr_b16 v[138:139], v202 offset:9216
    ds_read_b64_tr_b16 v[140:141], v203 offset:8192
    ds_read_b64_tr_b16 v[142:143], v203 offset:9216
    s_add_u32 m0, s48, 114688
    s_lshl_b32 s49, s51, 7
    s_add_u32 s49, s49, s46
    buffer_load_dwordx4 v20, s[8:11], s49 offen offset:0 lds
    s_waitcnt lgkmcnt(9)
    v_mfma_f32_32x32x16_bf16 v[112:127], v[156:159], v[164:167], v[112:127]
    buffer_load_dwordx4 v21, s[8:11], s49 offen offset:1024 lds
    s_waitcnt lgkmcnt(6)
    v_mfma_f32_32x32x16_bf16 v[64:79], v[128:131], v[160:163], v[64:79]
    ds_read_b128 v[164:167], v207 offset:0
    ds_read_b64_tr_b16 v[144:145], v200 offset:12288
    ds_read_b64_tr_b16 v[146:147], v200 offset:13312
    s_waitcnt lgkmcnt(7)
    v_mfma_f32_32x32x16_bf16 v[80:95], v[132:135], v[160:163], v[80:95]
    ds_read_b64_tr_b16 v[148:149], v201 offset:12288
    ds_read_b64_tr_b16 v[150:151], v201 offset:13312
    ds_read_b64_tr_b16 v[152:153], v202 offset:12288
    buffer_load_dwordx4 v22, s[8:11], s49 offen offset:2048 lds
    s_waitcnt lgkmcnt(8)
    v_mfma_f32_32x32x16_bf16 v[96:111], v[136:139], v[160:163], v[96:111]
    ds_read_b64_tr_b16 v[154:155], v202 offset:13312
    ds_read_b64_tr_b16 v[156:157], v203 offset:12288
    ds_read_b64_tr_b16 v[158:159], v203 offset:13312
    s_waitcnt lgkmcnt(9)
    v_mfma_f32_32x32x16_bf16 v[112:127], v[140:143], v[160:163], v[112:127]
    buffer_load_dwordx4 v23, s[8:11], s49 offen offset:3072 lds
    s_add_u32 s51, s51, 1
    s_cmp_eq_u32 s51, 10
    s_cselect_b32 s51, 0, s51
    s_waitcnt vmcnt(17)
    s_barrier
    s_waitcnt lgkmcnt(6)
    v_mfma_f32_32x32x16_bf16 v[64:79], v[144:147], v[164:167], v[64:79]
    ds_read_b128 v[160:163], v204 offset:32768
    ds_read_b64_tr_b16 v[128:129], v200 offset:32768
    ds_read_b64_tr_b16 v[130:131], v200 offset:33792
    s_waitcnt lgkmcnt(7)
    v_mfma_f32_32x32x16_bf16 v[80:95], v[148:151], v[164:167], v[80:95]
    ds_read_b64_tr_b16 v[132:133], v201 offset:32768
    ds_read_b64_tr_b16 v[134:135], v201 offset:33792
    ds_read_b64_tr_b16 v[136:137], v202 offset:32768
    s_add_u32 m0, s48, 131072
    s_lshl_b32 s49, s51, 19
    s_add_u32 s49, s49, s45
    buffer_load_dwordx4 v16, s[12:15], s49 offen offset:0 lds
    s_waitcnt lgkmcnt(8)
    v_mfma_f32_32x32x16_bf16 v[96:111], v[152:155], v[164:167], v[96:111]
    ds_read_b64_tr_b16 v[138:139], v202 offset:33792
    ds_read_b64_tr_b16 v[140:141], v203 offset:32768
    ds_read_b64_tr_b16 v[142:143], v203 offset:33792
    s_waitcnt lgkmcnt(9)
    v_mfma_f32_32x32x16_bf16 v[112:127], v[156:159], v[164:167], v[112:127]
    buffer_load_dwordx4 v17, s[12:15], s49 offen offset:1024 lds
    s_waitcnt lgkmcnt(6)
    v_mfma_f32_32x32x16_bf16 v[64:79], v[128:131], v[160:163], v[64:79]
    ds_read_b128 v[164:167], v205 offset:32768
    ds_read_b64_tr_b16 v[144:145], v200 offset:36864
    ds_read_b64_tr_b16 v[146:147], v200 offset:37888
    s_waitcnt lgkmcnt(7)
    v_mfma_f32_32x32x16_bf16 v[80:95], v[132:135], v[160:163], v[80:95]
    ds_read_b64_tr_b16 v[148:149], v201 offset:36864
    ds_read_b64_tr_b16 v[150:151], v201 offset:37888
    ds_read_b64_tr_b16 v[152:153], v202 offset:36864
    buffer_load_dwordx4 v18, s[12:15], s49 offen offset:2048 lds
    s_waitcnt lgkmcnt(8)
    v_mfma_f32_32x32x16_bf16 v[96:111], v[136:139], v[160:163], v[96:111]
    ds_read_b64_tr_b16 v[154:155], v202 offset:37888
    ds_read_b64_tr_b16 v[156:157], v203 offset:36864
    ds_read_b64_tr_b16 v[158:159], v203 offset:37888
    s_waitcnt lgkmcnt(9)
    v_mfma_f32_32x32x16_bf16 v[112:127], v[140:143], v[160:163], v[112:127]
    buffer_load_dwordx4 v19, s[12:15], s49 offen offset:3072 lds
    s_waitcnt lgkmcnt(6)
    v_mfma_f32_32x32x16_bf16 v[64:79], v[144:147], v[164:167], v[64:79]
    ds_read_b128 v[160:163], v206 offset:32768
    ds_read_b64_tr_b16 v[128:129], v200 offset:40960
    ds_read_b64_tr_b16 v[130:131], v200 offset:41984
    s_waitcnt lgkmcnt(7)
    v_mfma_f32_32x32x16_bf16 v[80:95], v[148:151], v[164:167], v[80:95]
    ds_read_b64_tr_b16 v[132:133], v201 offset:40960
    ds_read_b64_tr_b16 v[134:135], v201 offset:41984
    ds_read_b64_tr_b16 v[136:137], v202 offset:40960
    s_add_u32 m0, s48, 147456
    s_lshl_b32 s49, s51, 7
    s_add_u32 s49, s49, s46
    buffer_load_dwordx4 v20, s[8:11], s49 offen offset:0 lds
    s_waitcnt lgkmcnt(8)
    v_mfma_f32_32x32x16_bf16 v[96:111], v[152:155], v[164:167], v[96:111]
    ds_read_b64_tr_b16 v[138:139], v202 offset:41984
    ds_read_b64_tr_b16 v[140:141], v203 offset:40960
    ds_read_b64_tr_b16 v[142:143], v203 offset:41984
    s_waitcnt lgkmcnt(9)
    v_mfma_f32_32x32x16_bf16 v[112:127], v[156:159], v[164:167], v[112:127]
    buffer_load_dwordx4 v21, s[8:11], s49 offen offset:1024 lds
    s_waitcnt lgkmcnt(6)
    v_mfma_f32_32x32x16_bf16 v[64:79], v[128:131], v[160:163], v[64:79]
    ds_read_b128 v[164:167], v207 offset:32768
    ds_read_b64_tr_b16 v[144:145], v200 offset:45056
    ds_read_b64_tr_b16 v[146:147], v200 offset:46080
    s_waitcnt lgkmcnt(7)
    v_mfma_f32_32x32x16_bf16 v[80:95], v[132:135], v[160:163], v[80:95]
    ds_read_b64_tr_b16 v[148:149], v201 offset:45056
    ds_read_b64_tr_b16 v[150:151], v201 offset:46080
    ds_read_b64_tr_b16 v[152:153], v202 offset:45056
    buffer_load_dwordx4 v22, s[8:11], s49 offen offset:2048 lds
    s_waitcnt lgkmcnt(8)
    v_mfma_f32_32x32x16_bf16 v[96:111], v[136:139], v[160:163], v[96:111]
    ds_read_b64_tr_b16 v[154:155], v202 offset:46080
    ds_read_b64_tr_b16 v[156:157], v203 offset:45056
    ds_read_b64_tr_b16 v[158:159], v203 offset:46080
    s_waitcnt lgkmcnt(9)
    v_mfma_f32_32x32x16_bf16 v[112:127], v[140:143], v[160:163], v[112:127]
    buffer_load_dwordx4 v23, s[8:11], s49 offen offset:3072 lds
    s_add_u32 s51, s51, 1
    s_cmp_eq_u32 s51, 10
    s_cselect_b32 s51, 0, s51
    s_waitcnt vmcnt(16)
    s_barrier
    s_waitcnt lgkmcnt(6)
    v_mfma_f32_32x32x16_bf16 v[64:79], v[144:147], v[164:167], v[64:79]
    ds_read_b128 v[160:163], v212 offset:0
    ds_read_b64_tr_b16 v[128:129], v208 offset:0
    ds_read_b64_tr_b16 v[130:131], v208 offset:1024
    s_waitcnt lgkmcnt(7)
    v_mfma_f32_32x32x16_bf16 v[80:95], v[148:151], v[164:167], v[80:95]
    ds_read_b64_tr_b16 v[132:133], v209 offset:0
    ds_read_b64_tr_b16 v[134:135], v209 offset:1024
    ds_read_b64_tr_b16 v[136:137], v210 offset:0
    s_add_u32 m0, s48, 0
    s_lshl_b32 s49, s51, 19
    s_add_u32 s49, s49, s45
    buffer_load_dwordx4 v16, s[12:15], s49 offen offset:0 lds
    s_waitcnt lgkmcnt(8)
    v_mfma_f32_32x32x16_bf16 v[96:111], v[152:155], v[164:167], v[96:111]
    ds_read_b64_tr_b16 v[138:139], v210 offset:1024
    ds_read_b64_tr_b16 v[140:141], v211 offset:0
    ds_read_b64_tr_b16 v[142:143], v211 offset:1024
    s_waitcnt lgkmcnt(9)
    v_mfma_f32_32x32x16_bf16 v[112:127], v[156:159], v[164:167], v[112:127]
    buffer_load_dwordx4 v17, s[12:15], s49 offen offset:1024 lds
    s_waitcnt lgkmcnt(6)
    v_mfma_f32_32x32x16_bf16 v[64:79], v[128:131], v[160:163], v[64:79]
    ds_read_b128 v[164:167], v213 offset:0
    ds_read_b64_tr_b16 v[144:145], v208 offset:4096
    ds_read_b64_tr_b16 v[146:147], v208 offset:5120
    s_waitcnt lgkmcnt(7)
    v_mfma_f32_32x32x16_bf16 v[80:95], v[132:135], v[160:163], v[80:95]
    ds_read_b64_tr_b16 v[148:149], v209 offset:4096
    ds_read_b64_tr_b16 v[150:151], v209 offset:5120
    ds_read_b64_tr_b16 v[152:153], v210 offset:4096
    buffer_load_dwordx4 v18, s[12:15], s49 offen offset:2048 lds
    s_waitcnt lgkmcnt(8)
    v_mfma_f32_32x32x16_bf16 v[96:111], v[136:139], v[160:163], v[96:111]
    ds_read_b64_tr_b16 v[154:155], v210 offset:5120
    ds_read_b64_tr_b16 v[156:157], v211 offset:4096
    ds_read_b64_tr_b16 v[158:159], v211 offset:5120
    s_waitcnt lgkmcnt(9)
    v_mfma_f32_32x32x16_bf16 v[112:127], v[140:143], v[160:163], v[112:127]
    buffer_load_dwordx4 v19, s[12:15], s49 offen offset:3072 lds
    s_waitcnt lgkmcnt(6)
    v_mfma_f32_32x32x16_bf16 v[64:79], v[144:147], v[164:167], v[64:79]
    ds_read_b128 v[160:163], v214 offset:0
    ds_read_b64_tr_b16 v[128:129], v208 offset:8192
    ds_read_b64_tr_b16 v[130:131], v208 offset:9216
    s_waitcnt lgkmcnt(7)
    v_mfma_f32_32x32x16_bf16 v[80:95], v[148:151], v[164:167], v[80:95]
    ds_read_b64_tr_b16 v[132:133], v209 offset:8192
    ds_read_b64_tr_b16 v[134:135], v209 offset:9216
    ds_read_b64_tr_b16 v[136:137], v210 offset:8192
    s_add_u32 m0, s48, 16384
    s_lshl_b32 s49, s51, 7
    s_add_u32 s49, s49, s46
    buffer_load_dwordx4 v20, s[8:11], s49 offen offset:0 lds
    s_waitcnt lgkmcnt(8)
    v_mfma_f32_32x32x16_bf16 v[96:111], v[152:155], v[164:167], v[96:111]
    ds_read_b64_tr_b16 v[138:139], v210 offset:9216
    ds_read_b64_tr_b16 v[140:141], v211 offset:8192
    ds_read_b64_tr_b16 v[142:143], v211 offset:9216
    s_waitcnt lgkmcnt(9)
    v_mfma_f32_32x32x16_bf16 v[112:127], v[156:159], v[164:167], v[112:127]
    buffer_load_dwordx4 v21, s[8:11], s49 offen offset:1024 lds
    s_waitcnt lgkmcnt(6)
    v_mfma_f32_32x32x16_bf16 v[64:79], v[128:131], v[160:163], v[64:79]
    ds_read_b128 v[164:167], v215 offset:0
    ds_read_b64_tr_b16 v[144:145], v208 offset:12288
    ds_read_b64_tr_b16 v[146:147], v208 offset:13312
    s_waitcnt lgkmcnt(7)
    v_mfma_f32_32x32x16_bf16 v[80:95], v[132:135], v[160:163], v[80:95]
    ds_read_b64_tr_b16 v[148:149], v209 offset:12288
    ds_read_b64_tr_b16 v[150:151], v209 offset:13312
    ds_read_b64_tr_b16 v[152:153], v210 offset:12288
    buffer_load_dwordx4 v22, s[8:11], s49 offen offset:2048 lds
    s_waitcnt lgkmcnt(8)
    v_mfma_f32_32x32x16_bf16 v[96:111], v[136:139], v[160:163], v[96:111]
    ds_read_b64_tr_b16 v[154:155], v210 offset:13312
    ds_read_b64_tr_b16 v[156:157], v211 offset:12288
    ds_read_b64_tr_b16 v[158:159], v211 offset:13312
    s_waitcnt lgkmcnt(9)
    v_mfma_f32_32x32x16_bf16 v[112:127], v[140:143], v[160:163], v[112:127]
    buffer_load_dwordx4 v23, s[8:11], s49 offen offset:3072 lds
    s_add_u32 s51, s51, 1
    s_cmp_eq_u32 s51, 10
    s_cselect_b32 s51, 0, s51
    s_waitcnt vmcnt(16)
    s_barrier
    s_waitcnt lgkmcnt(6)
    v_mfma_f32_32x32x16_bf16 v[64:79], v[144:147], v[164:167], v[64:79]
    ds_read_b128 v[160:163], v212 offset:32768
    ds_read_b64_tr_b16 v[128:129], v208 offset:32768
    ds_read_b64_tr_b16 v[130:131], v208 offset:33792
    s_waitcnt lgkmcnt(7)
    v_mfma_f32_32x32x16_bf16 v[80:95], v[148:151], v[164:167], v[80:95]
    ds_read_b64_tr_b16 v[132:133], v209 offset:32768
    ds_read_b64_tr_b16 v[134:135], v209 offset:33792
    ds_read_b64_tr_b16 v[136:137], v210 offset:32768
    s_add_u32 m0, s48, 32768
    s_lshl_b32 s49, s51, 19
    s_add_u32 s49, s49, s45
    buffer_load_dwordx4 v16, s[12:15], s49 offen offset:0 lds
    s_waitcnt lgkmcnt(8)
    v_mfma_f32_32x32x16_bf16 v[96:111], v[152:155], v[164:167], v[96:111]
    ds_read_b64_tr_b16 v[138:139], v210 offset:33792
    ds_read_b64_tr_b16 v[140:141], v211 offset:32768
    ds_read_b64_tr_b16 v[142:143], v211 offset:33792
    buffer_load_dwordx4 v17, s[12:15], s49 offen offset:1024 lds
    s_waitcnt lgkmcnt(9)
    v_mfma_f32_32x32x16_bf16 v[112:127], v[156:159], v[164:167], v[112:127]
    buffer_load_dwordx4 v18, s[12:15], s49 offen offset:2048 lds
    s_waitcnt lgkmcnt(6)
    v_mfma_f32_32x32x16_bf16 v[64:79], v[128:131], v[160:163], v[64:79]
    ds_read_b128 v[164:167], v213 offset:32768
    ds_read_b64_tr_b16 v[144:145], v208 offset:36864
    ds_read_b64_tr_b16 v[146:147], v208 offset:37888
    s_waitcnt lgkmcnt(7)
    v_mfma_f32_32x32x16_bf16 v[80:95], v[132:135], v[160:163], v[80:95]
    ds_read_b64_tr_b16 v[148:149], v209 offset:36864
    ds_read_b64_tr_b16 v[150:151], v209 offset:37888
    ds_read_b64_tr_b16 v[152:153], v210 offset:36864
    buffer_load_dwordx4 v19, s[12:15], s49 offen offset:3072 lds
    s_waitcnt lgkmcnt(8)
    v_mfma_f32_32x32x16_bf16 v[96:111], v[136:139], v[160:163], v[96:111]
    ds_read_b64_tr_b16 v[154:155], v210 offset:37888
    ds_read_b64_tr_b16 v[156:157], v211 offset:36864
    ds_read_b64_tr_b16 v[158:159], v211 offset:37888
    s_waitcnt lgkmcnt(9)
    v_mfma_f32_32x32x16_bf16 v[112:127], v[140:143], v[160:163], v[112:127]
    s_add_u32 m0, s48, 49152
    s_lshl_b32 s49, s51, 7
    s_add_u32 s49, s49, s46
    buffer_load_dwordx4 v20, s[8:11], s49 offen offset:0 lds
    s_waitcnt lgkmcnt(6)
    v_mfma_f32_32x32x16_bf16 v[64:79], v[144:147], v[164:167], v[64:79]
    ds_read_b128 v[160:163], v214 offset:32768
    ds_read_b64_tr_b16 v[128:129], v208 offset:40960
    ds_read_b64_tr_b16 v[130:131], v208 offset:41984
    s_waitcnt lgkmcnt(7)
    v_mfma_f32_32x32x16_bf16 v[80:95], v[148:151], v[164:167], v[80:95]
    ds_read_b64_tr_b16 v[132:133], v209 offset:40960
    ds_read_b64_tr_b16 v[134:135], v209 offset:41984
    ds_read_b64_tr_b16 v[136:137], v210 offset:40960
    buffer_load_dwordx4 v21, s[8:11], s49 offen offset:1024 lds
    s_waitcnt lgkmcnt(8)
    v_mfma_f32_32x32x16_bf16 v[96:111], v[152:155], v[164:167], v[96:111]
    ds_read_b64_tr_b16 v[138:139], v210 offset:41984
    ds_read_b64_tr_b16 v[140:141], v211 offset:40960
    ds_read_b64_tr_b16 v[142:143], v211 offset:41984
    s_waitcnt lgkmcnt(9)
    v_mfma_f32_32x32x16_bf16 v[112:127], v[156:159], v[164:167], v[112:127]
    buffer_load_dwordx4 v22, s[8:11], s49 offen offset:2048 lds
    s_waitcnt lgkmcnt(6)
    v_mfma_f32_32x32x16_bf16 v[64:79], v[128:131], v[160:163], v[64:79]
    ds_read_b128 v[164:167], v215 offset:32768
    ds_read_b64_tr_b16 v[144:145], v208 offset:45056
    ds_read_b64_tr_b16 v[146:147], v208 offset:46080
    s_waitcnt lgkmcnt(7)
    v_mfma_f32_32x32x16_bf16 v[80:95], v[132:135], v[160:163], v[80:95]
    ds_read_b64_tr_b16 v[148:149], v209 offset:45056
    ds_read_b64_tr_b16 v[150:151], v209 offset:46080
    ds_read_b64_tr_b16 v[152:153], v210 offset:45056
    buffer_load_dwordx4 v23, s[8:11], s49 offen offset:3072 lds
    s_add_u32 s51, s51, 1
    s_cmp_eq_u32 s51, 10
    s_cselect_b32 s51, 0, s51
    s_waitcnt lgkmcnt(8)
    v_mfma_f32_32x32x16_bf16 v[96:111], v[136:139], v[160:163], v[96:111]
    ds_read_b64_tr_b16 v[154:155], v210 offset:46080
    ds_read_b64_tr_b16 v[156:157], v211 offset:45056
    ds_read_b64_tr_b16 v[158:159], v211 offset:46080
    s_waitcnt lgkmcnt(9)
    v_mfma_f32_32x32x16_bf16 v[112:127], v[140:143], v[160:163], v[112:127]
    buffer_load_dword v14, v63, s[24:27], s96 offen
    s_waitcnt vmcnt(17)
    s_barrier
    s_waitcnt lgkmcnt(6)
    v_mfma_f32_32x32x16_bf16 v[64:79], v[144:147], v[164:167], v[64:79]
    ds_read_b128 v[160:163], v220 offset:0
    ds_read_b64_tr_b16 v[128:129], v216 offset:0
    ds_read_b64_tr_b16 v[130:131], v216 offset:1024
    s_waitcnt lgkmcnt(7)
    v_mfma_f32_32x32x16_bf16 v[80:95], v[148:151], v[164:167], v[80:95]
    ds_read_b64_tr_b16 v[132:133], v217 offset:0
    ds_read_b64_tr_b16 v[134:135], v217 offset:1024
    ds_read_b64_tr_b16 v[136:137], v218 offset:0
    s_add_u32 m0, s48, 65536
    s_lshl_b32 s49, s51, 19
    s_add_u32 s49, s49, s45
    buffer_load_dwordx4 v16, s[12:15], s49 offen offset:0 lds
    s_waitcnt lgkmcnt(8)
    v_mfma_f32_32x32x16_bf16 v[96:111], v[152:155], v[164:167], v[96:111]
    ds_read_b64_tr_b16 v[138:139], v218 offset:1024
    ds_read_b64_tr_b16 v[140:141], v219 offset:0
    ds_read_b64_tr_b16 v[142:143], v219 offset:1024
    s_waitcnt lgkmcnt(9)
    v_mfma_f32_32x32x16_bf16 v[112:127], v[156:159], v[164:167], v[112:127]
    buffer_load_dwordx4 v17, s[12:15], s49 offen offset:1024 lds
    s_waitcnt lgkmcnt(6)
    v_mfma_f32_32x32x16_bf16 v[64:79], v[128:131], v[160:163], v[64:79]
    ds_read_b128 v[164:167], v221 offset:0
    ds_read_b64_tr_b16 v[144:145], v216 offset:4096
    ds_read_b64_tr_b16 v[146:147], v216 offset:5120
    s_waitcnt lgkmcnt(7)
    v_mfma_f32_32x32x16_bf16 v[80:95], v[132:135], v[160:163], v[80:95]
    ds_read_b64_tr_b16 v[148:149], v217 offset:4096
    ds_read_b64_tr_b16 v[150:151], v217 offset:5120
    ds_read_b64_tr_b16 v[152:153], v218 offset:4096
    buffer_load_dwordx4 v18, s[12:15], s49 offen offset:2048 lds
    s_waitcnt lgkmcnt(8)
    v_mfma_f32_32x32x16_bf16 v[96:111], v[136:139], v[160:163], v[96:111]
    ds_read_b64_tr_b16 v[154:155], v218 offset:5120
    ds_read_b64_tr_b16 v[156:157], v219 offset:4096
    ds_read_b64_tr_b16 v[158:159], v219 offset:5120
    s_waitcnt lgkmcnt(9)
    v_mfma_f32_32x32x16_bf16 v[112:127], v[140:143], v[160:163], v[112:127]
    buffer_load_dwordx4 v19, s[12:15], s49 offen offset:3072 lds
    s_waitcnt lgkmcnt(6)
    v_mfma_f32_32x32x16_bf16 v[64:79], v[144:147], v[164:167], v[64:79]
    ds_read_b128 v[160:163], v222 offset:0
    ds_read_b64_tr_b16 v[128:129], v216 offset:8192
    ds_read_b64_tr_b16 v[130:131], v216 offset:9216
    s_waitcnt lgkmcnt(7)
    v_mfma_f32_32x32x16_bf16 v[80:95], v[148:151], v[164:167], v[80:95]
    ds_read_b64_tr_b16 v[132:133], v217 offset:8192
    ds_read_b64_tr_b16 v[134:135], v217 offset:9216
    ds_read_b64_tr_b16 v[136:137], v218 offset:8192
    s_add_u32 m0, s48, 81920
    s_lshl_b32 s49, s51, 7
    s_add_u32 s49, s49, s46
    buffer_load_dwordx4 v20, s[8:11], s49 offen offset:0 lds
    s_waitcnt lgkmcnt(8)
    v_mfma_f32_32x32x16_bf16 v[96:111], v[152:155], v[164:167], v[96:111]
    ds_read_b64_tr_b16 v[138:139], v218 offset:9216
    ds_read_b64_tr_b16 v[140:141], v219 offset:8192
    ds_read_b64_tr_b16 v[142:143], v219 offset:9216
    s_waitcnt lgkmcnt(9)
    v_mfma_f32_32x32x16_bf16 v[112:127], v[156:159], v[164:167], v[112:127]
    buffer_load_dwordx4 v21, s[8:11], s49 offen offset:1024 lds
    s_waitcnt lgkmcnt(6)
    v_mfma_f32_32x32x16_bf16 v[64:79], v[128:131], v[160:163], v[64:79]
    ds_read_b128 v[164:167], v223 offset:0
    ds_read_b64_tr_b16 v[144:145], v216 offset:12288
    ds_read_b64_tr_b16 v[146:147], v216 offset:13312
    s_waitcnt lgkmcnt(7)
    v_mfma_f32_32x32x16_bf16 v[80:95], v[132:135], v[160:163], v[80:95]
    ds_read_b64_tr_b16 v[148:149], v217 offset:12288
    ds_read_b64_tr_b16 v[150:151], v217 offset:13312
    ds_read_b64_tr_b16 v[152:153], v218 offset:12288
    buffer_load_dwordx4 v22, s[8:11], s49 offen offset:2048 lds
    s_waitcnt lgkmcnt(8)
    v_mfma_f32_32x32x16_bf16 v[96:111], v[136:139], v[160:163], v[96:111]
    ds_read_b64_tr_b16 v[154:155], v218 offset:13312
    ds_read_b64_tr_b16 v[156:157], v219 offset:12288
    ds_read_b64_tr_b16 v[158:159], v219 offset:13312
    s_waitcnt lgkmcnt(9)
    v_mfma_f32_32x32x16_bf16 v[112:127], v[140:143], v[160:163], v[112:127]
    buffer_load_dwordx4 v23, s[8:11], s49 offen offset:3072 lds
    s_add_u32 s51, s51, 1
    s_cmp_eq_u32 s51, 10
    s_cselect_b32 s51, 0, s51
    s_waitcnt vmcnt(17)
    s_barrier
    s_waitcnt lgkmcnt(6)
    v_mfma_f32_32x32x16_bf16 v[64:79], v[144:147], v[164:167], v[64:79]
    ds_read_b128 v[160:163], v204 offset:0
    ds_read_b64_tr_b16 v[128:129], v200 offset:0
    ds_read_b64_tr_b16 v[130:131], v200 offset:1024
    s_waitcnt lgkmcnt(7)
    v_mfma_f32_32x32x16_bf16 v[80:95], v[148:151], v[164:167], v[80:95]
    ds_read_b64_tr_b16 v[132:133], v201 offset:0
    ds_read_b64_tr_b16 v[134:135], v201 offset:1024
    ds_read_b64_tr_b16 v[136:137], v202 offset:0
    s_add_u32 m0, s48, 98304
    s_lshl_b32 s49, s51, 19
    s_add_u32 s49, s49, s45
    buffer_load_dwordx4 v16, s[12:15], s49 offen offset:0 lds
    s_waitcnt lgkmcnt(8)
    v_mfma_f32_32x32x16_bf16 v[96:111], v[152:155], v[164:167], v[96:111]
    ds_read_b64_tr_b16 v[138:139], v202 offset:1024
    ds_read_b64_tr_b16 v[140:141], v203 offset:0
    ds_read_b64_tr_b16 v[142:143], v203 offset:1024
    s_waitcnt lgkmcnt(9)
    v_mfma_f32_32x32x16_bf16 v[112:127], v[156:159], v[164:167], v[112:127]
    buffer_load_dwordx4 v17, s[12:15], s49 offen offset:1024 lds
    s_waitcnt lgkmcnt(6)
    v_mfma_f32_32x32x16_bf16 v[64:79], v[128:131], v[160:163], v[64:79]
    ds_read_b128 v[164:167], v205 offset:0
    ds_read_b64_tr_b16 v[144:145], v200 offset:4096
    ds_read_b64_tr_b16 v[146:147], v200 offset:5120
    s_waitcnt lgkmcnt(7)
    v_mfma_f32_32x32x16_bf16 v[80:95], v[132:135], v[160:163], v[80:95]
    ds_read_b64_tr_b16 v[148:149], v201 offset:4096
    ds_read_b64_tr_b16 v[150:151], v201 offset:5120
    ds_read_b64_tr_b16 v[152:153], v202 offset:4096
    buffer_load_dwordx4 v18, s[12:15], s49 offen offset:2048 lds
    s_waitcnt lgkmcnt(8)
    v_mfma_f32_32x32x16_bf16 v[96:111], v[136:139], v[160:163], v[96:111]
    ds_read_b64_tr_b16 v[154:155], v202 offset:5120
    ds_read_b64_tr_b16 v[156:157], v203 offset:4096
    ds_read_b64_tr_b16 v[158:159], v203 offset:5120
    s_waitcnt lgkmcnt(9)
    v_mfma_f32_32x32x16_bf16 v[112:127], v[140:143], v[160:163], v[112:127]
    buffer_load_dwordx4 v19, s[12:15], s49 offen offset:3072 lds
    s_waitcnt lgkmcnt(6)
    v_mfma_f32_32x32x16_bf16 v[64:79], v[144:147], v[164:167], v[64:79]
    ds_read_b128 v[160:163], v206 offset:0
    ds_read_b64_tr_b16 v[128:129], v200 offset:8192
    ds_read_b64_tr_b16 v[130:131], v200 offset:9216
    s_waitcnt lgkmcnt(7)
    v_mfma_f32_32x32x16_bf16 v[80:95], v[148:151], v[164:167], v[80:95]
    ds_read_b64_tr_b16 v[132:133], v201 offset:8192
    ds_read_b64_tr_b16 v[134:135], v201 offset:9216
    ds_read_b64_tr_b16 v[136:137], v202 offset:8192
    s_add_u32 m0, s48, 114688
    s_lshl_b32 s49, s51, 7
    s_add_u32 s49, s49, s46
    buffer_load_dwordx4 v20, s[8:11], s49 offen offset:0 lds
    s_waitcnt lgkmcnt(8)
    v_mfma_f32_32x32x16_bf16 v[96:111], v[152:155], v[164:167], v[96:111]
    ds_read_b64_tr_b16 v[138:139], v202 offset:9216
    ds_read_b64_tr_b16 v[140:141], v203 offset:8192
    ds_read_b64_tr_b16 v[142:143], v203 offset:9216
    s_waitcnt lgkmcnt(9)
    v_mfma_f32_32x32x16_bf16 v[112:127], v[156:159], v[164:167], v[112:127]
    buffer_load_dwordx4 v21, s[8:11], s49 offen offset:1024 lds
    s_waitcnt lgkmcnt(6)
    v_mfma_f32_32x32x16_bf16 v[64:79], v[128:131], v[160:163], v[64:79]
    ds_read_b128 v[164:167], v207 offset:0
    ds_read_b64_tr_b16 v[144:145], v200 offset:12288
    ds_read_b64_tr_b16 v[146:147], v200 offset:13312
    s_waitcnt lgkmcnt(7)
    v_mfma_f32_32x32x16_bf16 v[80:95], v[132:135], v[160:163], v[80:95]
    ds_read_b64_tr_b16 v[148:149], v201 offset:12288
    ds_read_b64_tr_b16 v[150:151], v201 offset:13312
    ds_read_b64_tr_b16 v[152:153], v202 offset:12288
    buffer_load_dwordx4 v22, s[8:11], s49 offen offset:2048 lds
    s_waitcnt lgkmcnt(8)
    v_mfma_f32_32x32x16_bf16 v[96:111], v[136:139], v[160:163], v[96:111]
    ds_read_b64_tr_b16 v[154:155], v202 offset:13312
    ds_read_b64_tr_b16 v[156:157], v203 offset:12288
    ds_read_b64_tr_b16 v[158:159], v203 offset:13312
    s_waitcnt lgkmcnt(9)
    v_mfma_f32_32x32x16_bf16 v[112:127], v[140:143], v[160:163], v[112:127]
    buffer_load_dwordx4 v23, s[8:11], s49 offen offset:3072 lds
    s_add_u32 s51, s51, 1
    s_cmp_eq_u32 s51, 10
    s_cselect_b32 s51, 0, s51
    s_waitcnt vmcnt(17)
    s_barrier
    s_waitcnt lgkmcnt(6)
    v_mfma_f32_32x32x16_bf16 v[64:79], v[144:147], v[164:167], v[64:79]
    ds_read_b128 v[160:163], v204 offset:32768
    ds_read_b64_tr_b16 v[128:129], v200 offset:32768
    ds_read_b64_tr_b16 v[130:131], v200 offset:33792
    s_waitcnt lgkmcnt(7)
    v_mfma_f32_32x32x16_bf16 v[80:95], v[148:151], v[164:167], v[80:95]
    ds_read_b64_tr_b16 v[132:133], v201 offset:32768
    ds_read_b64_tr_b16 v[134:135], v201 offset:33792
    ds_read_b64_tr_b16 v[136:137], v202 offset:32768
    s_add_u32 m0, s48, 131072
    s_lshl_b32 s49, s51, 19
    s_add_u32 s49, s49, s45
    buffer_load_dwordx4 v16, s[12:15], s49 offen offset:0 lds
    s_waitcnt lgkmcnt(8)
    v_mfma_f32_32x32x16_bf16 v[96:111], v[152:155], v[164:167], v[96:111]
    ds_read_b64_tr_b16 v[138:139], v202 offset:33792
    ds_read_b64_tr_b16 v[140:141], v203 offset:32768
    ds_read_b64_tr_b16 v[142:143], v203 offset:33792
    s_waitcnt lgkmcnt(9)
    v_mfma_f32_32x32x16_bf16 v[112:127], v[156:159], v[164:167], v[112:127]
    buffer_load_dwordx4 v17, s[12:15], s49 offen offset:1024 lds
    s_waitcnt lgkmcnt(6)
    v_mfma_f32_32x32x16_bf16 v[64:79], v[128:131], v[160:163], v[64:79]
    ds_read_b128 v[164:167], v205 offset:32768
    ds_read_b64_tr_b16 v[144:145], v200 offset:36864
    ds_read_b64_tr_b16 v[146:147], v200 offset:37888
    s_waitcnt lgkmcnt(7)
    v_mfma_f32_32x32x16_bf16 v[80:95], v[132:135], v[160:163], v[80:95]
    ds_read_b64_tr_b16 v[148:149], v201 offset:36864
    ds_read_b64_tr_b16 v[150:151], v201 offset:37888
    ds_read_b64_tr_b16 v[152:153], v202 offset:36864
    buffer_load_dwordx4 v18, s[12:15], s49 offen offset:2048 lds
    s_waitcnt lgkmcnt(8)
    v_mfma_f32_32x32x16_bf16 v[96:111], v[136:139], v[160:163], v[96:111]
    ds_read_b64_tr_b16 v[154:155], v202 offset:37888
    ds_read_b64_tr_b16 v[156:157], v203 offset:36864
    ds_read_b64_tr_b16 v[158:159], v203 offset:37888
    s_waitcnt lgkmcnt(9)
    v_mfma_f32_32x32x16_bf16 v[112:127], v[140:143], v[160:163], v[112:127]
    buffer_load_dwordx4 v19, s[12:15], s49 offen offset:3072 lds
    s_waitcnt lgkmcnt(6)
    v_mfma_f32_32x32x16_bf16 v[64:79], v[144:147], v[164:167], v[64:79]
    ds_read_b128 v[160:163], v206 offset:32768
    ds_read_b64_tr_b16 v[128:129], v200 offset:40960
    ds_read_b64_tr_b16 v[130:131], v200 offset:41984
    s_waitcnt lgkmcnt(7)
    v_mfma_f32_32x32x16_bf16 v[80:95], v[148:151], v[164:167], v[80:95]
    ds_read_b64_tr_b16 v[132:133], v201 offset:40960
    ds_read_b64_tr_b16 v[134:135], v201 offset:41984
    ds_read_b64_tr_b16 v[136:137], v202 offset:40960
    s_add_u32 m0, s48, 147456
    s_lshl_b32 s49, s51, 7
    s_add_u32 s49, s49, s46
    buffer_load_dwordx4 v20, s[8:11], s49 offen offset:0 lds
    s_waitcnt lgkmcnt(8)
    v_mfma_f32_32x32x16_bf16 v[96:111], v[152:155], v[164:167], v[96:111]
    ds_read_b64_tr_b16 v[138:139], v202 offset:41984
    ds_read_b64_tr_b16 v[140:141], v203 offset:40960
    ds_read_b64_tr_b16 v[142:143], v203 offset:41984
    s_waitcnt lgkmcnt(9)
    v_mfma_f32_32x32x16_bf16 v[112:127], v[156:159], v[164:167], v[112:127]
    buffer_load_dwordx4 v21, s[8:11], s49 offen offset:1024 lds
    s_waitcnt lgkmcnt(6)
    v_mfma_f32_32x32x16_bf16 v[64:79], v[128:131], v[160:163], v[64:79]
    ds_read_b128 v[164:167], v207 offset:32768
    ds_read_b64_tr_b16 v[144:145], v200 offset:45056
    ds_read_b64_tr_b16 v[146:147], v200 offset:46080
    s_waitcnt lgkmcnt(7)
    v_mfma_f32_32x32x16_bf16 v[80:95], v[132:135], v[160:163], v[80:95]
    ds_read_b64_tr_b16 v[148:149], v201 offset:45056
    ds_read_b64_tr_b16 v[150:151], v201 offset:46080
    ds_read_b64_tr_b16 v[152:153], v202 offset:45056
    buffer_load_dwordx4 v22, s[8:11], s49 offen offset:2048 lds
    s_waitcnt lgkmcnt(8)
    v_mfma_f32_32x32x16_bf16 v[96:111], v[136:139], v[160:163], v[96:111]
    ds_read_b64_tr_b16 v[154:155], v202 offset:46080
    ds_read_b64_tr_b16 v[156:157], v203 offset:45056
    ds_read_b64_tr_b16 v[158:159], v203 offset:46080
    s_waitcnt lgkmcnt(9)
    v_mfma_f32_32x32x16_bf16 v[112:127], v[140:143], v[160:163], v[112:127]
    buffer_load_dwordx4 v23, s[8:11], s49 offen offset:3072 lds
    s_add_u32 s51, s51, 1
    s_cmp_eq_u32 s51, 10
    s_cselect_b32 s51, 0, s51
    s_waitcnt vmcnt(16)
    s_barrier
    s_waitcnt lgkmcnt(6)
    v_mfma_f32_32x32x16_bf16 v[64:79], v[144:147], v[164:167], v[64:79]
    ds_read_b128 v[160:163], v212 offset:0
    ds_read_b64_tr_b16 v[128:129], v208 offset:0
    ds_read_b64_tr_b16 v[130:131], v208 offset:1024
    s_waitcnt lgkmcnt(7)
    v_mfma_f32_32x32x16_bf16 v[80:95], v[148:151], v[164:167], v[80:95]
    ds_read_b64_tr_b16 v[132:133], v209 offset:0
    ds_read_b64_tr_b16 v[134:135], v209 offset:1024
    ds_read_b64_tr_b16 v[136:137], v210 offset:0
    s_add_u32 m0, s50, 0
    s_add_u32 s49, s47, 0
    buffer_load_dwordx4 v24, s[16:19], s49 offen offset:0 nt lds
    s_waitcnt lgkmcnt(8)
    v_mfma_f32_32x32x16_bf16 v[96:111], v[152:155], v[164:167], v[96:111]
    ds_read_b64_tr_b16 v[138:139], v210 offset:1024
    ds_read_b64_tr_b16 v[140:141], v211 offset:0
    ds_read_b64_tr_b16 v[142:143], v211 offset:1024
    s_waitcnt lgkmcnt(9)
    v_mfma_f32_32x32x16_bf16 v[112:127], v[156:159], v[164:167], v[112:127]
    buffer_load_dwordx4 v25, s[16:19], s49 offen offset:1024 nt lds
    s_waitcnt lgkmcnt(6)
    v_mfma_f32_32x32x16_bf16 v[64:79], v[128:131], v[160:163], v[64:79]
    ds_read_b128 v[164:167], v213 offset:0
    ds_read_b64_tr_b16 v[144:145], v208 offset:4096
    ds_read_b64_tr_b16 v[146:147], v208 offset:5120
    s_waitcnt lgkmcnt(7)
    v_mfma_f32_32x32x16_bf16 v[80:95], v[132:135], v[160:163], v[80:95]
    ds_read_b64_tr_b16 v[148:149], v209 offset:4096
    ds_read_b64_tr_b16 v[150:151], v209 offset:5120
    ds_read_b64_tr_b16 v[152:153], v210 offset:4096
    buffer_load_dwordx4 v26, s[16:19], s49 offen offset:2048 nt lds
    s_waitcnt lgkmcnt(8)
    v_mfma_f32_32x32x16_bf16 v[96:111], v[136:139], v[160:163], v[96:111]
    ds_read_b64_tr_b16 v[154:155], v210 offset:5120
    ds_read_b64_tr_b16 v[156:157], v211 offset:4096
    ds_read_b64_tr_b16 v[158:159], v211 offset:5120
    s_waitcnt lgkmcnt(9)
    v_mfma_f32_32x32x16_bf16 v[112:127], v[140:143], v[160:163], v[112:127]
    buffer_load_dwordx4 v27, s[16:19], s49 offen offset:3072 nt lds
    s_waitcnt lgkmcnt(6)
    v_mfma_f32_32x32x16_bf16 v[64:79], v[144:147], v[164:167], v[64:79]
    ds_read_b128 v[160:163], v214 offset:0
    ds_read_b64_tr_b16 v[128:129], v208 offset:8192
    ds_read_b64_tr_b16 v[130:131], v208 offset:9216
    s_waitcnt lgkmcnt(7)
    v_mfma_f32_32x32x16_bf16 v[80:95], v[148:151], v[164:167], v[80:95]
    ds_read_b64_tr_b16 v[132:133], v209 offset:8192
    ds_read_b64_tr_b16 v[134:135], v209 offset:9216
    ds_read_b64_tr_b16 v[136:137], v210 offset:8192
    s_add_u32 m0, s50, 4096
    s_add_u32 s49, s47, 4096
    buffer_load_dwordx4 v24, s[16:19], s49 offen offset:0 nt lds
    s_waitcnt lgkmcnt(8)
    v_mfma_f32_32x32x16_bf16 v[96:111], v[152:155], v[164:167], v[96:111]
    ds_read_b64_tr_b16 v[138:139], v210 offset:9216
    ds_read_b64_tr_b16 v[140:141], v211 offset:8192
    ds_read_b64_tr_b16 v[142:143], v211 offset:9216
    s_waitcnt lgkmcnt(9)
    v_mfma_f32_32x32x16_bf16 v[112:127], v[156:159], v[164:167], v[112:127]
    buffer_load_dwordx4 v25, s[16:19], s49 offen offset:1024 nt lds
    s_waitcnt lgkmcnt(6)
    v_mfma_f32_32x32x16_bf16 v[64:79], v[128:131], v[160:163], v[64:79]
    ds_read_b128 v[164:167], v215 offset:0
    ds_read_b64_tr_b16 v[144:145], v208 offset:12288
    ds_read_b64_tr_b16 v[146:147], v208 offset:13312
    s_waitcnt lgkmcnt(7)
    v_mfma_f32_32x32x16_bf16 v[80:95], v[132:135], v[160:163], v[80:95]
    ds_read_b64_tr_b16 v[148:149], v209 offset:12288
    ds_read_b64_tr_b16 v[150:151], v209 offset:13312
    ds_read_b64_tr_b16 v[152:153], v210 offset:12288
    buffer_load_dwordx4 v26, s[16:19], s49 offen offset:2048 nt lds
    s_waitcnt lgkmcnt(8)
    v_mfma_f32_32x32x16_bf16 v[96:111], v[136:139], v[160:163], v[96:111]
    ds_read_b64_tr_b16 v[154:155], v210 offset:13312
    ds_read_b64_tr_b16 v[156:157], v211 offset:12288
    ds_read_b64_tr_b16 v[158:159], v211 offset:13312
    s_waitcnt lgkmcnt(9)
    v_mfma_f32_32x32x16_bf16 v[112:127], v[140:143], v[160:163], v[112:127]
    buffer_load_dwordx4 v27, s[16:19], s49 offen offset:3072 nt lds
    s_waitcnt vmcnt(16)
    s_barrier
    s_waitcnt lgkmcnt(6)
    v_mfma_f32_32x32x16_bf16 v[64:79], v[144:147], v[164:167], v[64:79]
    ds_read_b128 v[160:163], v212 offset:32768
    ds_read_b64_tr_b16 v[128:129], v208 offset:32768
    ds_read_b64_tr_b16 v[130:131], v208 offset:33792
    s_waitcnt lgkmcnt(7)
    v_mfma_f32_32x32x16_bf16 v[80:95], v[148:151], v[164:167], v[80:95]
    ds_read_b64_tr_b16 v[132:133], v209 offset:32768
    ds_read_b64_tr_b16 v[134:135], v209 offset:33792
    ds_read_b64_tr_b16 v[136:137], v210 offset:32768
    s_add_u32 m0, s50, 32768
    s_add_u32 s49, s47, 0
    buffer_load_dwordx4 v28, s[20:23], s49 offen offset:0 nt lds
    s_waitcnt lgkmcnt(8)
    v_mfma_f32_32x32x16_bf16 v[96:111], v[152:155], v[164:167], v[96:111]
    ds_read_b64_tr_b16 v[138:139], v210 offset:33792
    ds_read_b64_tr_b16 v[140:141], v211 offset:32768
    ds_read_b64_tr_b16 v[142:143], v211 offset:33792
    s_waitcnt lgkmcnt(9)
    v_mfma_f32_32x32x16_bf16 v[112:127], v[156:159], v[164:167], v[112:127]
    buffer_load_dwordx4 v28, s[20:23], s49 offen offset:1024 nt lds
    s_waitcnt lgkmcnt(6)
    v_mfma_f32_32x32x16_bf16 v[64:79], v[128:131], v[160:163], v[64:79]
    ds_read_b128 v[164:167], v213 offset:32768
    ds_read_b64_tr_b16 v[144:145], v208 offset:36864
    ds_read_b64_tr_b16 v[146:147], v208 offset:37888
    s_waitcnt lgkmcnt(7)
    v_mfma_f32_32x32x16_bf16 v[80:95], v[132:135], v[160:163], v[80:95]
    ds_read_b64_tr_b16 v[148:149], v209 offset:36864
    ds_read_b64_tr_b16 v[150:151], v209 offset:37888
    ds_read_b64_tr_b16 v[152:153], v210 offset:36864
    buffer_load_dwordx4 v28, s[20:23], s49 offen offset:2048 nt lds
    s_waitcnt lgkmcnt(8)
    v_mfma_f32_32x32x16_bf16 v[96:111], v[136:139], v[160:163], v[96:111]
    ds_read_b64_tr_b16 v[154:155], v210 offset:37888
    ds_read_b64_tr_b16 v[156:157], v211 offset:36864
    ds_read_b64_tr_b16 v[158:159], v211 offset:37888
    s_waitcnt lgkmcnt(9)
    v_mfma_f32_32x32x16_bf16 v[112:127], v[140:143], v[160:163], v[112:127]
    buffer_load_dwordx4 v28, s[20:23], s49 offen offset:3072 nt lds
    s_waitcnt lgkmcnt(6)
    v_mfma_f32_32x32x16_bf16 v[64:79], v[144:147], v[164:167], v[64:79]
    ds_read_b128 v[160:163], v214 offset:32768
    ds_read_b64_tr_b16 v[128:129], v208 offset:40960
    ds_read_b64_tr_b16 v[130:131], v208 offset:41984
    s_waitcnt lgkmcnt(7)
    v_mfma_f32_32x32x16_bf16 v[80:95], v[148:151], v[164:167], v[80:95]
    ds_read_b64_tr_b16 v[132:133], v209 offset:40960
    ds_read_b64_tr_b16 v[134:135], v209 offset:41984
    ds_read_b64_tr_b16 v[136:137], v210 offset:40960
    s_add_u32 m0, s50, 36864
    s_add_u32 s49, s47, 4096
    buffer_load_dwordx4 v28, s[20:23], s49 offen offset:0 nt lds
    s_waitcnt lgkmcnt(8)
    v_mfma_f32_32x32x16_bf16 v[96:111], v[152:155], v[164:167], v[96:111]
    ds_read_b64_tr_b16 v[138:139], v210 offset:41984
    ds_read_b64_tr_b16 v[140:141], v211 offset:40960
    ds_read_b64_tr_b16 v[142:143], v211 offset:41984
    s_waitcnt lgkmcnt(9)
    v_mfma_f32_32x32x16_bf16 v[112:127], v[156:159], v[164:167], v[112:127]
    buffer_load_dwordx4 v28, s[20:23], s49 offen offset:1024 nt lds
    s_waitcnt lgkmcnt(6)
    v_mfma_f32_32x32x16_bf16 v[64:79], v[128:131], v[160:163], v[64:79]
    ds_read_b128 v[164:167], v215 offset:32768
    ds_read_b64_tr_b16 v[144:145], v208 offset:45056
    ds_read_b64_tr_b16 v[146:147], v208 offset:46080
    s_waitcnt lgkmcnt(7)
    v_mfma_f32_32x32x16_bf16 v[80:95], v[132:135], v[160:163], v[80:95]
    ds_read_b64_tr_b16 v[148:149], v209 offset:45056
    ds_read_b64_tr_b16 v[150:151], v209 offset:46080
    ds_read_b64_tr_b16 v[152:153], v210 offset:45056
    buffer_load_dwordx4 v28, s[20:23], s49 offen offset:2048 nt lds
    s_waitcnt lgkmcnt(8)
    v_mfma_f32_32x32x16_bf16 v[96:111], v[136:139], v[160:163], v[96:111]
    ds_read_b64_tr_b16 v[154:155], v210 offset:46080
    ds_read_b64_tr_b16 v[156:157], v211 offset:45056
    ds_read_b64_tr_b16 v[158:159], v211 offset:46080
    s_waitcnt lgkmcnt(9)
    v_mfma_f32_32x32x16_bf16 v[112:127], v[140:143], v[160:163], v[112:127]
    buffer_load_dwordx4 v28, s[20:23], s49 offen offset:3072 nt lds
    s_waitcnt vmcnt(16)
    s_barrier
    s_waitcnt lgkmcnt(6)
    v_mfma_f32_32x32x16_bf16 v[64:79], v[144:147], v[164:167], v[64:79]
    ds_read_b128 v[160:163], v220 offset:0
    ds_read_b64_tr_b16 v[128:129], v216 offset:0
    ds_read_b64_tr_b16 v[130:131], v216 offset:1024
    s_waitcnt lgkmcnt(7)
    v_mfma_f32_32x32x16_bf16 v[80:95], v[148:151], v[164:167], v[80:95]
    ds_read_b64_tr_b16 v[132:133], v217 offset:0
    ds_read_b64_tr_b16 v[134:135], v217 offset:1024
    ds_read_b64_tr_b16 v[136:137], v218 offset:0
    s_waitcnt lgkmcnt(8)
    v_mfma_f32_32x32x16_bf16 v[96:111], v[152:155], v[164:167], v[96:111]
    ds_read_b64_tr_b16 v[138:139], v218 offset:1024
    ds_read_b64_tr_b16 v[140:141], v219 offset:0
    ds_read_b64_tr_b16 v[142:143], v219 offset:1024
    s_waitcnt lgkmcnt(9)
    v_mfma_f32_32x32x16_bf16 v[112:127], v[156:159], v[164:167], v[112:127]
    s_waitcnt lgkmcnt(6)
    v_mfma_f32_32x32x16_bf16 v[64:79], v[128:131], v[160:163], v[64:79]
    ds_read_b128 v[164:167], v221 offset:0
    ds_read_b64_tr_b16 v[144:145], v216 offset:4096
    ds_read_b64_tr_b16 v[146:147], v216 offset:5120
    s_waitcnt lgkmcnt(7)
    v_mfma_f32_32x32x16_bf16 v[80:95], v[132:135], v[160:163], v[80:95]
    ds_read_b64_tr_b16 v[148:149], v217 offset:4096
    ds_read_b64_tr_b16 v[150:151], v217 offset:5120
    ds_read_b64_tr_b16 v[152:153], v218 offset:4096
    s_waitcnt lgkmcnt(8)
    v_mfma_f32_32x32x16_bf16 v[96:111], v[136:139], v[160:163], v[96:111]
    ds_read_b64_tr_b16 v[154:155], v218 offset:5120
    ds_read_b64_tr_b16 v[156:157], v219 offset:4096
    ds_read_b64_tr_b16 v[158:159], v219 offset:5120
    s_waitcnt lgkmcnt(9)
    v_mfma_f32_32x32x16_bf16 v[112:127], v[140:143], v[160:163], v[112:127]
    s_waitcnt lgkmcnt(6)
    v_mfma_f32_32x32x16_bf16 v[64:79], v[144:147], v[164:167], v[64:79]
    ds_read_b128 v[160:163], v222 offset:0
    ds_read_b64_tr_b16 v[128:129], v216 offset:8192
    ds_read_b64_tr_b16 v[130:131], v216 offset:9216
    s_waitcnt lgkmcnt(7)
    v_mfma_f32_32x32x16_bf16 v[80:95], v[148:151], v[164:167], v[80:95]
    ds_read_b64_tr_b16 v[132:133], v217 offset:8192
    ds_read_b64_tr_b16 v[134:135], v217 offset:9216
    ds_read_b64_tr_b16 v[136:137], v218 offset:8192
    s_waitcnt lgkmcnt(8)
    v_mfma_f32_32x32x16_bf16 v[96:111], v[152:155], v[164:167], v[96:111]
    ds_read_b64_tr_b16 v[138:139], v218 offset:9216
    ds_read_b64_tr_b16 v[140:141], v219 offset:8192
    ds_read_b64_tr_b16 v[142:143], v219 offset:9216
    s_waitcnt lgkmcnt(9)
    v_mfma_f32_32x32x16_bf16 v[112:127], v[156:159], v[164:167], v[112:127]
    s_waitcnt lgkmcnt(6)
    v_mfma_f32_32x32x16_bf16 v[64:79], v[128:131], v[160:163], v[64:79]
    ds_read_b128 v[164:167], v223 offset:0
    ds_read_b64_tr_b16 v[144:145], v216 offset:12288
    ds_read_b64_tr_b16 v[146:147], v216 offset:13312
    s_waitcnt lgkmcnt(7)
    v_mfma_f32_32x32x16_bf16 v[80:95], v[132:135], v[160:163], v[80:95]
    ds_read_b64_tr_b16 v[148:149], v217 offset:12288
    ds_read_b64_tr_b16 v[150:151], v217 offset:13312
    ds_read_b64_tr_b16 v[152:153], v218 offset:12288
    s_waitcnt lgkmcnt(8)
    v_mfma_f32_32x32x16_bf16 v[96:111], v[136:139], v[160:163], v[96:111]
    ds_read_b64_tr_b16 v[154:155], v218 offset:13312
    ds_read_b64_tr_b16 v[156:157], v219 offset:12288
    ds_read_b64_tr_b16 v[158:159], v219 offset:13312
    s_waitcnt lgkmcnt(9)
    v_mfma_f32_32x32x16_bf16 v[112:127], v[140:143], v[160:163], v[112:127]
    s_waitcnt vmcnt(8) lgkmcnt(0)
    s_barrier
    v_mfma_f32_32x32x16_bf16 v[64:79], v[144:147], v[164:167], v[64:79]
    ds_read_b128 v[128:131], v32 offset:0
    ds_read_b128 v[132:135], v32 offset:8192
    ds_read_b128 v[136:139], v33 offset:0
    v_mfma_f32_32x32x16_bf16 v[80:95], v[148:151], v[164:167], v[80:95]
    ds_read_b128 v[140:143], v33 offset:8192
    v_mfma_f32_32x32x16_bf16 v[96:111], v[152:155], v[164:167], v[96:111]
    v_mfma_f32_32x32x16_bf16 v[112:127], v[156:159], v[164:167], v[112:127]
    ds_read_b128 v[144:147], v34 offset:0
    ds_read_b128 v[148:151], v34 offset:8192
    ds_read_b128 v[152:155], v35 offset:0
    ds_read_b128 v[156:159], v35 offset:8192
    s_nop 4
    v_cvt_pk_bf16_f32 v168, v64, v65
    v_cvt_pk_bf16_f32 v169, v66, v67
    v_cvt_pk_bf16_f32 v170, v68, v69
    v_cvt_pk_bf16_f32 v171, v70, v71
    v_cvt_pk_bf16_f32 v172, v72, v73
    v_cvt_pk_bf16_f32 v173, v74, v75
    v_cvt_pk_bf16_f32 v174, v76, v77
    v_cvt_pk_bf16_f32 v175, v78, v79
    v_cvt_pk_bf16_f32 v176, v80, v81
    v_cvt_pk_bf16_f32 v177, v82, v83
    v_cvt_pk_bf16_f32 v178, v84, v85
    v_cvt_pk_bf16_f32 v179, v86, v87
    v_cvt_pk_bf16_f32 v180, v88, v89
    v_cvt_pk_bf16_f32 v181, v90, v91
    v_cvt_pk_bf16_f32 v182, v92, v93
    v_cvt_pk_bf16_f32 v183, v94, v95
    v_cvt_pk_bf16_f32 v184, v96, v97
    v_cvt_pk_bf16_f32 v185, v98, v99
    v_cvt_pk_bf16_f32 v186, v100, v101
    v_cvt_pk_bf16_f32 v187, v102, v103
    v_cvt_pk_bf16_f32 v188, v104, v105
    v_cvt_pk_bf16_f32 v189, v106, v107
    v_cvt_pk_bf16_f32 v190, v108, v109
    v_cvt_pk_bf16_f32 v191, v110, v111
    s_nop 1
    s_waitcnt lgkmcnt(7)
    v_mfma_f32_32x32x16_bf16 v[200:215], v[128:131], v[168:171], 0
    ds_read_b128 v[128:131], v36 offset:0
    s_add_u32 s41, s36, 13
    s_and_b32 s41, s41, 31
    s_mul_i32 s41, s41, 5120
    s_mov_b32 m0, s41
    s_add_u32 s49, s52, 0
    buffer_load_dwordx4 v44, s[24:27], s49 offen offset:0 lds
    s_waitcnt lgkmcnt(7)
    v_mfma_f32_32x32x16_bf16 v[216:231], v[132:135], v[168:171], 0
    ds_read_b128 v[132:135], v36 offset:8192
    buffer_load_dwordx4 v45, s[24:27], s49 offen offset:1024 lds
    s_waitcnt lgkmcnt(7)
    v_mfma_f32_32x32x16_bf16 v[200:215], v[136:139], v[172:175], v[200:215]
    ds_read_b128 v[136:139], v37 offset:0
    buffer_load_dwordx4 v46, s[24:27], s49 offen offset:2048 lds
    s_waitcnt lgkmcnt(7)
    v_mfma_f32_32x32x16_bf16 v[216:231], v[140:143], v[172:175], v[216:231]
    ds_read_b128 v[140:143], v37 offset:8192
    buffer_load_dwordx4 v47, s[24:27], s49 offen offset:3072 lds
    v_cvt_pk_bf16_f32 v192, v112, v113
    v_cvt_pk_bf16_f32 v193, v114, v115
    v_cvt_pk_bf16_f32 v194, v116, v117
    v_cvt_pk_bf16_f32 v195, v118, v119
    v_cvt_pk_bf16_f32 v196, v120, v121
    v_cvt_pk_bf16_f32 v197, v122, v123
    v_cvt_pk_bf16_f32 v198, v124, v125
    v_cvt_pk_bf16_f32 v199, v126, v127
    s_nop 0
    s_waitcnt lgkmcnt(7)
    v_mfma_f32_32x32x16_bf16 v[200:215], v[144:147], v[176:179], v[200:215]
    ds_read_b128 v[144:147], v38 offset:0
    s_add_u32 m0, s41, 4096
    s_nop 0
    buffer_load_dwordx4 v48, s[24:27], s49 offen offset:0 lds
    s_waitcnt lgkmcnt(7)
    v_mfma_f32_32x32x16_bf16 v[216:231], v[148:151], v[176:179], v[216:231]
    ds_read_b128 v[148:151], v38 offset:8192
    s_add_u32 s41, s36, 17
    s_and_b32 s41, s41, 31
    s_mul_i32 s41, s41, 5120
    s_mov_b32 m0, s41
    s_add_u32 s49, s52, 81920
    buffer_load_dwordx4 v44, s[24:27], s49 offen offset:0 lds
    s_waitcnt lgkmcnt(7)
    v_mfma_f32_32x32x16_bf16 v[200:215], v[152:155], v[180:183], v[200:215]
    ds_read_b128 v[152:155], v39 offset:0
    buffer_load_dwordx4 v45, s[24:27], s49 offen offset:1024 lds
    s_waitcnt lgkmcnt(7)
    v_mfma_f32_32x32x16_bf16 v[216:231], v[156:159], v[180:183], v[216:231]
    ds_read_b128 v[156:159], v39 offset:8192
    buffer_load_dwordx4 v46, s[24:27], s49 offen offset:2048 lds
    s_waitcnt lgkmcnt(7)
    v_mfma_f32_32x32x16_bf16 v[200:215], v[128:131], v[184:187], v[200:215]
    buffer_load_dwordx4 v47, s[24:27], s49 offen offset:3072 lds
    s_waitcnt lgkmcnt(6)
    v_mfma_f32_32x32x16_bf16 v[216:231], v[132:135], v[184:187], v[216:231]
    s_add_u32 m0, s41, 4096
    s_nop 0
    buffer_load_dwordx4 v48, s[24:27], s49 offen offset:0 lds
    s_waitcnt lgkmcnt(5)
    v_mfma_f32_32x32x16_bf16 v[200:215], v[136:139], v[188:191], v[200:215]
    s_waitcnt lgkmcnt(4)
    v_mfma_f32_32x32x16_bf16 v[216:231], v[140:143], v[188:191], v[216:231]
    s_waitcnt lgkmcnt(3)
    v_mfma_f32_32x32x16_bf16 v[200:215], v[144:147], v[192:195], v[200:215]
    s_waitcnt lgkmcnt(2)
    v_mfma_f32_32x32x16_bf16 v[216:231], v[148:151], v[192:195], v[216:231]
    s_waitcnt lgkmcnt(1)
    v_mfma_f32_32x32x16_bf16 v[200:215], v[152:155], v[196:199], v[200:215]
    s_waitcnt lgkmcnt(0)
    v_mfma_f32_32x32x16_bf16 v[216:231], v[156:159], v[196:199], v[216:231]
    s_waitcnt vmcnt(10)
    s_barrier
    ds_read_b64_tr_b16 v[128:129], v40 offset:0
    ds_read_b64_tr_b16 v[130:131], v40 offset:2048
    ds_read_b64_tr_b16 v[132:133], v40 offset:4096
    ds_read_b64_tr_b16 v[134:135], v40 offset:6144
    ds_read_b64_tr_b16 v[136:137], v40 offset:8192
    ds_read_b64_tr_b16 v[138:139], v40 offset:10240
    ds_read_b64_tr_b16 v[140:141], v40 offset:12288
    ds_read_b64_tr_b16 v[142:143], v40 offset:14336
    ds_read_b64_tr_b16 v[144:145], v41 offset:0
    ds_read_b64_tr_b16 v[146:147], v41 offset:2048
    ds_read_b64_tr_b16 v[148:149], v41 offset:4096
    ds_read_b64_tr_b16 v[150:151], v41 offset:6144
    ds_read_b64_tr_b16 v[152:153], v41 offset:8192
    ds_read_b64_tr_b16 v[154:155], v41 offset:10240
    ds_read_b64_tr_b16 v[156:157], v41 offset:12288
    ds_read_b64_tr_b16 v[158:159], v41 offset:14336
    v_max3_f32 v52, v200, v201, v202
    v_max3_f32 v53, v203, v204, v205
    v_max3_f32 v52, v52, v206, v207
    v_max3_f32 v53, v53, v208, v209
    v_max3_f32 v52, v52, v210, v211
    v_max3_f32 v53, v53, v212, v213
    v_max3_f32 v52, v52, v214, v215
    v_max3_f32 v52, v52, v216, v217
    v_max3_f32 v53, v53, v218, v219
    v_max3_f32 v52, v52, v220, v221
    v_max3_f32 v53, v53, v222, v223
    v_max3_f32 v52, v52, v224, v225
    v_max3_f32 v53, v53, v226, v227
    v_max3_f32 v52, v52, v228, v229
    v_max3_f32 v53, v53, v230, v231
    v_max_f32 v52, v52, v53
    v_mov_b32 v53, v52
    s_mov_b32 s42, 0x3e0293ee
    s_nop 0
    v_permlane32_swap_b32 v52, v53
    s_nop 0
    v_max_f32 v52, v52, v53
    v_mul_f32 v52, s42, v52
    s_mov_b32 s62, s42
    s_mov_b32 s63, s42
    v_pk_fma_f32 v[200:201], v[200:201], s[62:63], v[52:53] op_sel_hi:[1,1,0] neg_lo:[0,0,1] neg_hi:[0,0,1]
    v_pk_fma_f32 v[202:203], v[202:203], s[62:63], v[52:53] op_sel_hi:[1,1,0] neg_lo:[0,0,1] neg_hi:[0,0,1]
    v_pk_fma_f32 v[204:205], v[204:205], s[62:63], v[52:53] op_sel_hi:[1,1,0] neg_lo:[0,0,1] neg_hi:[0,0,1]
    v_pk_fma_f32 v[206:207], v[206:207], s[62:63], v[52:53] op_sel_hi:[1,1,0] neg_lo:[0,0,1] neg_hi:[0,0,1]
    v_pk_fma_f32 v[208:209], v[208:209], s[62:63], v[52:53] op_sel_hi:[1,1,0] neg_lo:[0,0,1] neg_hi:[0,0,1]
    v_pk_fma_f32 v[210:211], v[210:211], s[62:63], v[52:53] op_sel_hi:[1,1,0] neg_lo:[0,0,1] neg_hi:[0,0,1]
    v_pk_fma_f32 v[212:213], v[212:213], s[62:63], v[52:53] op_sel_hi:[1,1,0] neg_lo:[0,0,1] neg_hi:[0,0,1]
    v_pk_fma_f32 v[214:215], v[214:215], s[62:63], v[52:53] op_sel_hi:[1,1,0] neg_lo:[0,0,1] neg_hi:[0,0,1]
    v_pk_fma_f32 v[216:217], v[216:217], s[62:63], v[52:53] op_sel_hi:[1,1,0] neg_lo:[0,0,1] neg_hi:[0,0,1]
    v_pk_fma_f32 v[218:219], v[218:219], s[62:63], v[52:53] op_sel_hi:[1,1,0] neg_lo:[0,0,1] neg_hi:[0,0,1]
    v_pk_fma_f32 v[220:221], v[220:221], s[62:63], v[52:53] op_sel_hi:[1,1,0] neg_lo:[0,0,1] neg_hi:[0,0,1]
    v_pk_fma_f32 v[222:223], v[222:223], s[62:63], v[52:53] op_sel_hi:[1,1,0] neg_lo:[0,0,1] neg_hi:[0,0,1]
    v_pk_fma_f32 v[224:225], v[224:225], s[62:63], v[52:53] op_sel_hi:[1,1,0] neg_lo:[0,0,1] neg_hi:[0,0,1]
    v_pk_fma_f32 v[226:227], v[226:227], s[62:63], v[52:53] op_sel_hi:[1,1,0] neg_lo:[0,0,1] neg_hi:[0,0,1]
    v_pk_fma_f32 v[228:229], v[228:229], s[62:63], v[52:53] op_sel_hi:[1,1,0] neg_lo:[0,0,1] neg_hi:[0,0,1]
    v_pk_fma_f32 v[230:231], v[230:231], s[62:63], v[52:53] op_sel_hi:[1,1,0] neg_lo:[0,0,1] neg_hi:[0,0,1]
    v_exp_f32 v200, v200
    v_exp_f32 v201, v201
    v_exp_f32 v202, v202
    s_add_u32 s41, s36, 21
    s_and_b32 s41, s41, 31
    s_mul_i32 s41, s41, 5120
    s_mov_b32 m0, s41
    s_add_u32 s49, s53, 0
    buffer_load_dwordx4 v44, s[24:27], s49 offen offset:0 lds
    v_exp_f32 v203, v203
    v_exp_f32 v204, v204
    v_exp_f32 v205, v205
    buffer_load_dwordx4 v45, s[24:27], s49 offen offset:1024 lds
    v_exp_f32 v206, v206
    v_exp_f32 v207, v207
    v_exp_f32 v208, v208
    buffer_load_dwordx4 v46, s[24:27], s49 offen offset:2048 lds
    v_exp_f32 v209, v209
    v_exp_f32 v210, v210
    v_exp_f32 v211, v211
    buffer_load_dwordx4 v47, s[24:27], s49 offen offset:3072 lds
    v_exp_f32 v212, v212
    v_exp_f32 v213, v213
    v_exp_f32 v214, v214
    s_add_u32 m0, s41, 4096
    s_nop 0
    buffer_load_dwordx4 v48, s[24:27], s49 offen offset:0 lds
    v_exp_f32 v215, v215
    v_exp_f32 v216, v216
    v_exp_f32 v217, v217
    s_add_u32 s41, s36, 25
    s_and_b32 s41, s41, 31
    s_mul_i32 s41, s41, 5120
    s_mov_b32 m0, s41
    s_add_u32 s49, s53, 81920
    buffer_load_dwordx4 v44, s[24:27], s49 offen offset:0 lds
    v_exp_f32 v218, v218
    v_exp_f32 v219, v219
    v_exp_f32 v220, v220
    buffer_load_dwordx4 v45, s[24:27], s49 offen offset:1024 lds
    v_exp_f32 v221, v221
    v_exp_f32 v222, v222
    v_exp_f32 v223, v223
    buffer_load_dwordx4 v46, s[24:27], s49 offen offset:2048 lds
    v_exp_f32 v224, v224
    v_exp_f32 v225, v225
    v_exp_f32 v226, v226
    buffer_load_dwordx4 v47, s[24:27], s49 offen offset:3072 lds
    v_exp_f32 v227, v227
    v_exp_f32 v228, v228
    v_exp_f32 v229, v229
    s_add_u32 m0, s41, 4096
    s_nop 0
    buffer_load_dwordx4 v48, s[24:27], s49 offen offset:0 lds
    v_exp_f32 v230, v230
    v_exp_f32 v231, v231
    s_nop 0
    v_pk_add_f32 v[54:55], v[200:201], v[202:203]
    v_pk_add_f32 v[56:57], v[204:205], v[206:207]
    v_pk_add_f32 v[54:55], v[54:55], v[208:209]
    v_pk_add_f32 v[56:57], v[56:57], v[210:211]
    v_pk_add_f32 v[54:55], v[54:55], v[212:213]
    v_pk_add_f32 v[56:57], v[56:57], v[214:215]
    v_pk_add_f32 v[54:55], v[54:55], v[216:217]
    v_pk_add_f32 v[56:57], v[56:57], v[218:219]
    v_pk_add_f32 v[54:55], v[54:55], v[220:221]
    v_pk_add_f32 v[56:57], v[56:57], v[222:223]
    v_pk_add_f32 v[54:55], v[54:55], v[224:225]
    v_pk_add_f32 v[56:57], v[56:57], v[226:227]
    v_pk_add_f32 v[54:55], v[54:55], v[228:229]
    v_pk_add_f32 v[56:57], v[56:57], v[230:231]
    v_pk_add_f32 v[54:55], v[54:55], v[56:57]
    v_add_f32 v54, v54, v55
    v_mov_b32 v56, v54
    s_nop 1
    v_permlane32_swap_b32 v54, v56
    s_nop 0
    v_add_f32 v54, v54, v56
    v_rcp_f32 v54, v54
    s_nop 0
    v_pk_mul_f32 v[200:201], v[200:201], v[54:55] op_sel_hi:[1,0]
    v_pk_mul_f32 v[202:203], v[202:203], v[54:55] op_sel_hi:[1,0]
    v_pk_mul_f32 v[204:205], v[204:205], v[54:55] op_sel_hi:[1,0]
    v_pk_mul_f32 v[206:207], v[206:207], v[54:55] op_sel_hi:[1,0]
    v_pk_mul_f32 v[208:209], v[208:209], v[54:55] op_sel_hi:[1,0]
    v_pk_mul_f32 v[210:211], v[210:211], v[54:55] op_sel_hi:[1,0]
    v_pk_mul_f32 v[212:213], v[212:213], v[54:55] op_sel_hi:[1,0]
    v_pk_mul_f32 v[214:215], v[214:215], v[54:55] op_sel_hi:[1,0]
    v_pk_mul_f32 v[216:217], v[216:217], v[54:55] op_sel_hi:[1,0]
    v_pk_mul_f32 v[218:219], v[218:219], v[54:55] op_sel_hi:[1,0]
    v_pk_mul_f32 v[220:221], v[220:221], v[54:55] op_sel_hi:[1,0]
    v_pk_mul_f32 v[222:223], v[222:223], v[54:55] op_sel_hi:[1,0]
    v_pk_mul_f32 v[224:225], v[224:225], v[54:55] op_sel_hi:[1,0]
    v_pk_mul_f32 v[226:227], v[226:227], v[54:55] op_sel_hi:[1,0]
    v_pk_mul_f32 v[228:229], v[228:229], v[54:55] op_sel_hi:[1,0]
    v_pk_mul_f32 v[230:231], v[230:231], v[54:55] op_sel_hi:[1,0]
    v_cvt_pk_bf16_f32 v232, v200, v201
    v_cvt_pk_bf16_f32 v233, v202, v203
    v_cvt_pk_bf16_f32 v234, v204, v205
    v_cvt_pk_bf16_f32 v235, v206, v207
    v_cvt_pk_bf16_f32 v236, v208, v209
    v_cvt_pk_bf16_f32 v237, v210, v211
    v_cvt_pk_bf16_f32 v238, v212, v213
    v_cvt_pk_bf16_f32 v239, v214, v215
    v_cvt_pk_bf16_f32 v240, v216, v217
    v_cvt_pk_bf16_f32 v241, v218, v219
    v_cvt_pk_bf16_f32 v242, v220, v221
    v_cvt_pk_bf16_f32 v243, v222, v223
    v_cvt_pk_bf16_f32 v244, v224, v225
    v_cvt_pk_bf16_f32 v245, v226, v227
    v_cvt_pk_bf16_f32 v246, v228, v229
    v_cvt_pk_bf16_f32 v247, v230, v231
    v_readlane_b32 s56, v29, 0
    v_readlane_b32 s57, v29, 1
    s_lshl_b32 s98, s39, 13
    s_add_u32 s98, s98, s58
    s_add_u32 s56, s56, 1
    s_add_u32 s57, s57, 1
    s_add_u32 s99, s98, 4096
    s_waitcnt lgkmcnt(14)
    v_mfma_f32_32x32x16_bf16 v[64:79], v[128:131], v[232:235], 0
    ds_read_b64_tr_b16 v[128:129], v42 offset:0
    ds_read_b64_tr_b16 v[130:131], v42 offset:2048
    s_waitcnt lgkmcnt(14)
    v_mfma_f32_32x32x16_bf16 v[64:79], v[132:135], v[236:239], v[64:79]
    ds_read_b64_tr_b16 v[132:133], v42 offset:4096
    ds_read_b64_tr_b16 v[134:135], v42 offset:6144
    s_waitcnt lgkmcnt(14)
    v_mfma_f32_32x32x16_bf16 v[64:79], v[136:139], v[240:243], v[64:79]
    ds_read_b64_tr_b16 v[136:137], v42 offset:8192
    ds_read_b64_tr_b16 v[138:139], v42 offset:10240
    s_waitcnt lgkmcnt(14)
    v_mfma_f32_32x32x16_bf16 v[64:79], v[140:143], v[244:247], v[64:79]
    ds_read_b64_tr_b16 v[140:141], v42 offset:12288
    ds_read_b64_tr_b16 v[142:143], v42 offset:14336
    s_waitcnt lgkmcnt(14)
    v_mfma_f32_32x32x16_bf16 v[80:95], v[144:147], v[232:235], 0
    ds_read_b64_tr_b16 v[144:145], v43 offset:0
    ds_read_b64_tr_b16 v[146:147], v43 offset:2048
    s_waitcnt lgkmcnt(14)
    v_mfma_f32_32x32x16_bf16 v[80:95], v[148:151], v[236:239], v[80:95]
    ds_read_b64_tr_b16 v[148:149], v43 offset:4096
    ds_read_b64_tr_b16 v[150:151], v43 offset:6144
    s_waitcnt lgkmcnt(14)
    v_mfma_f32_32x32x16_bf16 v[80:95], v[152:155], v[240:243], v[80:95]
    ds_read_b64_tr_b16 v[152:153], v43 offset:8192
    ds_read_b64_tr_b16 v[154:155], v43 offset:10240
    s_waitcnt lgkmcnt(14)
    v_mfma_f32_32x32x16_bf16 v[80:95], v[156:159], v[244:247], v[80:95]
    ds_read_b64_tr_b16 v[156:157], v43 offset:12288
    ds_read_b64_tr_b16 v[158:159], v43 offset:14336
    v_cvt_pk_bf16_f32 v168, v64, v65
    v_cvt_pk_bf16_f32 v169, v66, v67
    v_cvt_pk_bf16_f32 v170, v68, v69
    v_cvt_pk_bf16_f32 v171, v70, v71
    buffer_store_dwordx4 v[168:171], v30, s[32:35], s98 offen offset:0 sc1
    v_cvt_pk_bf16_f32 v172, v72, v73
    v_cvt_pk_bf16_f32 v173, v74, v75
    v_cvt_pk_bf16_f32 v174, v76, v77
    v_cvt_pk_bf16_f32 v175, v78, v79
    buffer_store_dwordx4 v[172:175], v30, s[32:35], s98 offen offset:1024 sc1
    s_waitcnt lgkmcnt(14)
    v_mfma_f32_32x32x16_bf16 v[96:111], v[128:131], v[232:235], 0
    s_waitcnt lgkmcnt(12)
    v_mfma_f32_32x32x16_bf16 v[96:111], v[132:135], v[236:239], v[96:111]
    s_waitcnt lgkmcnt(10)
    v_mfma_f32_32x32x16_bf16 v[96:111], v[136:139], v[240:243], v[96:111]
    s_waitcnt lgkmcnt(8)
    v_mfma_f32_32x32x16_bf16 v[96:111], v[140:143], v[244:247], v[96:111]
    s_nop 3
    v_cvt_pk_bf16_f32 v176, v80, v81
    v_cvt_pk_bf16_f32 v177, v82, v83
    v_cvt_pk_bf16_f32 v178, v84, v85
    v_cvt_pk_bf16_f32 v179, v86, v87
    buffer_store_dwordx4 v[176:179], v30, s[32:35], s98 offen offset:2048 sc1
    v_cvt_pk_bf16_f32 v180, v88, v89
    v_cvt_pk_bf16_f32 v181, v90, v91
    v_cvt_pk_bf16_f32 v182, v92, v93
    v_cvt_pk_bf16_f32 v183, v94, v95
    buffer_store_dwordx4 v[180:183], v30, s[32:35], s98 offen offset:3072 sc1
    s_waitcnt lgkmcnt(6)
    v_mfma_f32_32x32x16_bf16 v[112:127], v[144:147], v[232:235], 0
    s_waitcnt lgkmcnt(4)
    v_mfma_f32_32x32x16_bf16 v[112:127], v[148:151], v[236:239], v[112:127]
    s_waitcnt lgkmcnt(2)
    v_mfma_f32_32x32x16_bf16 v[112:127], v[152:155], v[240:243], v[112:127]
    s_waitcnt lgkmcnt(0)
    v_mfma_f32_32x32x16_bf16 v[112:127], v[156:159], v[244:247], v[112:127]
    s_nop 3
    v_cvt_pk_bf16_f32 v184, v96, v97
    v_cvt_pk_bf16_f32 v185, v98, v99
    v_cvt_pk_bf16_f32 v186, v100, v101
    v_cvt_pk_bf16_f32 v187, v102, v103
    buffer_store_dwordx4 v[184:187], v30, s[32:35], s99 offen offset:0 sc1
    v_cvt_pk_bf16_f32 v188, v104, v105
    v_cvt_pk_bf16_f32 v189, v106, v107
    v_cvt_pk_bf16_f32 v190, v108, v109
    v_cvt_pk_bf16_f32 v191, v110, v111
    buffer_store_dwordx4 v[188:191], v30, s[32:35], s99 offen offset:1024 sc1
    s_nop 3
    v_cvt_pk_bf16_f32 v192, v112, v113
    v_cvt_pk_bf16_f32 v193, v114, v115
    v_cvt_pk_bf16_f32 v194, v116, v117
    v_cvt_pk_bf16_f32 v195, v118, v119
    buffer_store_dwordx4 v[192:195], v30, s[32:35], s99 offen offset:2048 sc1
    v_cvt_pk_bf16_f32 v196, v120, v121
    v_cvt_pk_bf16_f32 v197, v122, v123
    v_cvt_pk_bf16_f32 v198, v124, v125
    v_cvt_pk_bf16_f32 v199, v126, v127
    buffer_store_dwordx4 v[196:199], v30, s[32:35], s99 offen offset:3072 sc1
    s_waitcnt vmcnt(18)
    s_barrier
    ds_read_b64_tr_b16 v[200:201], v50 offset:0
    ds_read_b64_tr_b16 v[202:203], v50 offset:2560
    ds_read_b64_tr_b16 v[204:205], v50 offset:64
    ds_read_b64_tr_b16 v[206:207], v50 offset:2624
    ds_read_b64_tr_b16 v[208:209], v50 offset:128
    ds_read_b64_tr_b16 v[210:211], v50 offset:2688
    ds_read_b64_tr_b16 v[212:213], v50 offset:192
    ds_read_b64_tr_b16 v[214:215], v50 offset:2752
    ds_read_b64_tr_b16 v[216:217], v50 offset:256
    ds_read_b64_tr_b16 v[218:219], v50 offset:2816
    s_lshr_b32 s43, s58, 15
    s_lshl_b32 s43, s43, 9
    s_add_u32 s43, s43, 0x2010000
    v_and_b32 v2, 3, v1
    v_lshlrev_b32 v2, 7, v2
    v_add_u32 v58, s43, v2
    s_lshl_b32 s42, s39, 7
    s_add_u32 s43, s43, s42
    v_mov_b32 v59, s43
    v_mov_b32 v60, s56
    s_waitcnt lgkmcnt(8)
    v_mfma_f32_32x32x16_bf16 v[64:79], v[200:203], v[168:171], 0
    ds_read_b64_tr_b16 v[220:221], v50 offset:5120
    ds_read_b64_tr_b16 v[222:223], v50 offset:7680
    ds_read_b64_tr_b16 v[224:225], v50 offset:5184
    s_waitcnt lgkmcnt(9)
    v_mfma_f32_32x32x16_bf16 v[80:95], v[204:207], v[168:171], 0
    ds_read_b64_tr_b16 v[226:227], v50 offset:7744
    ds_read_b64_tr_b16 v[228:229], v50 offset:5248
    ds_read_b64_tr_b16 v[230:231], v50 offset:7808
    s_waitcnt lgkmcnt(10)
    v_mfma_f32_32x32x16_bf16 v[96:111], v[208:211], v[168:171], 0
    ds_read_b64_tr_b16 v[232:233], v50 offset:5312
    ds_read_b64_tr_b16 v[234:235], v50 offset:7872
    s_waitcnt lgkmcnt(10)
    v_mfma_f32_32x32x16_bf16 v[112:127], v[212:215], v[168:171], 0
    ds_read_b64_tr_b16 v[236:237], v50 offset:5376
    ds_read_b64_tr_b16 v[238:239], v50 offset:7936
    s_waitcnt lgkmcnt(10)
    v_mfma_f32_32x32x16_bf16 v[128:143], v[216:219], v[168:171], 0
    s_waitcnt lgkmcnt(8)
    v_mfma_f32_32x32x16_bf16 v[64:79], v[220:223], v[172:175], v[64:79]
    ds_read_b64_tr_b16 v[200:201], v50 offset:10240
    ds_read_b64_tr_b16 v[202:203], v50 offset:12800
    ds_read_b64_tr_b16 v[204:205], v50 offset:10304
    s_waitcnt lgkmcnt(9)
    v_mfma_f32_32x32x16_bf16 v[80:95], v[224:227], v[172:175], v[80:95]
    ds_read_b64_tr_b16 v[206:207], v50 offset:12864
    ds_read_b64_tr_b16 v[208:209], v50 offset:10368
    ds_read_b64_tr_b16 v[210:211], v50 offset:12928
    s_waitcnt lgkmcnt(10)
    v_mfma_f32_32x32x16_bf16 v[96:111], v[228:231], v[172:175], v[96:111]
    ds_read_b64_tr_b16 v[212:213], v50 offset:10432
    ds_read_b64_tr_b16 v[214:215], v50 offset:12992
    s_waitcnt lgkmcnt(10)
    v_mfma_f32_32x32x16_bf16 v[112:127], v[232:235], v[172:175], v[112:127]
    ds_read_b64_tr_b16 v[216:217], v50 offset:10496
    ds_read_b64_tr_b16 v[218:219], v50 offset:13056
    s_waitcnt lgkmcnt(10)
    v_mfma_f32_32x32x16_bf16 v[128:143], v[236:239], v[172:175], v[128:143]
    s_waitcnt vmcnt(0)
    s_mov_b64 exec, 1
    buffer_store_dword v60, v59, s[32:35], 0 offen sc1
    s_mov_b64 exec, -1
    s_waitcnt lgkmcnt(8)
    v_mfma_f32_32x32x16_bf16 v[64:79], v[200:203], v[176:179], v[64:79]
    ds_read_b64_tr_b16 v[220:221], v50 offset:15360
    ds_read_b64_tr_b16 v[222:223], v50 offset:17920
    ds_read_b64_tr_b16 v[224:225], v50 offset:15424
    s_waitcnt lgkmcnt(9)
    v_mfma_f32_32x32x16_bf16 v[80:95], v[204:207], v[176:179], v[80:95]
    ds_read_b64_tr_b16 v[226:227], v50 offset:17984
    ds_read_b64_tr_b16 v[228:229], v50 offset:15488
    ds_read_b64_tr_b16 v[230:231], v50 offset:18048
    s_waitcnt lgkmcnt(10)
    v_mfma_f32_32x32x16_bf16 v[96:111], v[208:211], v[176:179], v[96:111]
    ds_read_b64_tr_b16 v[232:233], v50 offset:15552
    ds_read_b64_tr_b16 v[234:235], v50 offset:18112
    s_add_u32 s41, s36, 29
    s_and_b32 s41, s41, 31
    s_mul_i32 s41, s41, 5120
    s_mov_b32 m0, s41
    s_add_u32 s49, s54, 0
    buffer_load_dwordx4 v44, s[24:27], s49 offen offset:0 lds
    s_waitcnt lgkmcnt(10)
    v_mfma_f32_32x32x16_bf16 v[112:127], v[212:215], v[176:179], v[112:127]
    ds_read_b64_tr_b16 v[236:237], v50 offset:15616
    ds_read_b64_tr_b16 v[238:239], v50 offset:18176
    buffer_load_dwordx4 v45, s[24:27], s49 offen offset:1024 lds
    s_waitcnt lgkmcnt(10)
    v_mfma_f32_32x32x16_bf16 v[128:143], v[216:219], v[176:179], v[128:143]
    buffer_load_dwordx4 v46, s[24:27], s49 offen offset:2048 lds
    s_waitcnt lgkmcnt(8)
    v_mfma_f32_32x32x16_bf16 v[64:79], v[220:223], v[180:183], v[64:79]
    ds_read_b64_tr_b16 v[200:201], v50 offset:20480
    ds_read_b64_tr_b16 v[202:203], v50 offset:23040
    ds_read_b64_tr_b16 v[204:205], v50 offset:20544
    s_waitcnt lgkmcnt(9)
    v_mfma_f32_32x32x16_bf16 v[80:95], v[224:227], v[180:183], v[80:95]
    ds_read_b64_tr_b16 v[206:207], v50 offset:23104
    ds_read_b64_tr_b16 v[208:209], v50 offset:20608
    ds_read_b64_tr_b16 v[210:211], v50 offset:23168
    s_waitcnt lgkmcnt(10)
    v_mfma_f32_32x32x16_bf16 v[96:111], v[228:231], v[180:183], v[96:111]
    ds_read_b64_tr_b16 v[212:213], v50 offset:20672
    ds_read_b64_tr_b16 v[214:215], v50 offset:23232
    buffer_load_dwordx4 v47, s[24:27], s49 offen offset:3072 lds
    s_waitcnt lgkmcnt(10)
    v_mfma_f32_32x32x16_bf16 v[112:127], v[232:235], v[180:183], v[112:127]
    ds_read_b64_tr_b16 v[216:217], v50 offset:20736
    ds_read_b64_tr_b16 v[218:219], v50 offset:23296
    s_add_u32 m0, s41, 4096
    s_nop 0
    buffer_load_dwordx4 v48, s[24:27], s49 offen offset:0 lds
    s_waitcnt lgkmcnt(10)
    v_mfma_f32_32x32x16_bf16 v[128:143], v[236:239], v[180:183], v[128:143]
    s_add_u32 s41, s36, 33
    s_and_b32 s41, s41, 31
    s_mul_i32 s41, s41, 5120
    s_mov_b32 m0, s41
    s_add_u32 s49, s54, 81920
    buffer_load_dwordx4 v44, s[24:27], s49 offen offset:0 lds
    s_waitcnt lgkmcnt(8)
    v_mfma_f32_32x32x16_bf16 v[64:79], v[200:203], v[184:187], v[64:79]
    ds_read_b64_tr_b16 v[220:221], v50 offset:25600
    ds_read_b64_tr_b16 v[222:223], v50 offset:28160
    ds_read_b64_tr_b16 v[224:225], v50 offset:25664
    s_waitcnt lgkmcnt(9)
    v_mfma_f32_32x32x16_bf16 v[80:95], v[204:207], v[184:187], v[80:95]
    ds_read_b64_tr_b16 v[226:227], v50 offset:28224
    ds_read_b64_tr_b16 v[228:229], v50 offset:25728
    ds_read_b64_tr_b16 v[230:231], v50 offset:28288
    s_waitcnt lgkmcnt(10)
    v_mfma_f32_32x32x16_bf16 v[96:111], v[208:211], v[184:187], v[96:111]
    ds_read_b64_tr_b16 v[232:233], v50 offset:25792
    ds_read_b64_tr_b16 v[234:235], v50 offset:28352
    buffer_load_dwordx4 v45, s[24:27], s49 offen offset:1024 lds
    s_waitcnt lgkmcnt(10)
    v_mfma_f32_32x32x16_bf16 v[112:127], v[212:215], v[184:187], v[112:127]
    ds_read_b64_tr_b16 v[236:237], v50 offset:25856
    ds_read_b64_tr_b16 v[238:239], v50 offset:28416
    buffer_load_dwordx4 v46, s[24:27], s49 offen offset:2048 lds
    s_waitcnt lgkmcnt(10)
    v_mfma_f32_32x32x16_bf16 v[128:143], v[216:219], v[184:187], v[128:143]
    buffer_load_dwordx4 v47, s[24:27], s49 offen offset:3072 lds
    s_waitcnt lgkmcnt(8)
    v_mfma_f32_32x32x16_bf16 v[64:79], v[220:223], v[188:191], v[64:79]
    ds_read_b64_tr_b16 v[200:201], v50 offset:30720
    ds_read_b64_tr_b16 v[202:203], v50 offset:33280
    ds_read_b64_tr_b16 v[204:205], v50 offset:30784
    s_waitcnt lgkmcnt(9)
    v_mfma_f32_32x32x16_bf16 v[80:95], v[224:227], v[188:191], v[80:95]
    ds_read_b64_tr_b16 v[206:207], v50 offset:33344
    ds_read_b64_tr_b16 v[208:209], v50 offset:30848
    ds_read_b64_tr_b16 v[210:211], v50 offset:33408
    s_waitcnt lgkmcnt(10)
    v_mfma_f32_32x32x16_bf16 v[96:111], v[228:231], v[188:191], v[96:111]
    ds_read_b64_tr_b16 v[212:213], v50 offset:30912
    ds_read_b64_tr_b16 v[214:215], v50 offset:33472
    s_add_u32 m0, s41, 4096
    s_nop 0
    buffer_load_dwordx4 v48, s[24:27], s49 offen offset:0 lds
    s_waitcnt lgkmcnt(10)
    v_mfma_f32_32x32x16_bf16 v[112:127], v[232:235], v[188:191], v[112:127]
    ds_read_b64_tr_b16 v[216:217], v50 offset:30976
    ds_read_b64_tr_b16 v[218:219], v50 offset:33536
    s_add_u32 s41, s36, 37
    s_and_b32 s41, s41, 31
    s_mul_i32 s41, s41, 5120
    s_mov_b32 m0, s41
    s_add_u32 s49, s55, 0
    buffer_load_dwordx4 v44, s[24:27], s49 offen offset:0 lds
    s_waitcnt lgkmcnt(10)
    v_mfma_f32_32x32x16_bf16 v[128:143], v[236:239], v[188:191], v[128:143]
    buffer_load_dwordx4 v45, s[24:27], s49 offen offset:1024 lds
    s_waitcnt lgkmcnt(8)
    v_mfma_f32_32x32x16_bf16 v[64:79], v[200:203], v[192:195], v[64:79]
    ds_read_b64_tr_b16 v[220:221], v50 offset:35840
    ds_read_b64_tr_b16 v[222:223], v50 offset:38400
    ds_read_b64_tr_b16 v[224:225], v50 offset:35904
    s_waitcnt lgkmcnt(9)
    v_mfma_f32_32x32x16_bf16 v[80:95], v[204:207], v[192:195], v[80:95]
    ds_read_b64_tr_b16 v[226:227], v50 offset:38464
    ds_read_b64_tr_b16 v[228:229], v50 offset:35968
    ds_read_b64_tr_b16 v[230:231], v50 offset:38528
    s_waitcnt lgkmcnt(10)
    v_mfma_f32_32x32x16_bf16 v[96:111], v[208:211], v[192:195], v[96:111]
    ds_read_b64_tr_b16 v[232:233], v50 offset:36032
    ds_read_b64_tr_b16 v[234:235], v50 offset:38592
    buffer_load_dwordx4 v46, s[24:27], s49 offen offset:2048 lds
    s_waitcnt lgkmcnt(10)
    v_mfma_f32_32x32x16_bf16 v[112:127], v[212:215], v[192:195], v[112:127]
    ds_read_b64_tr_b16 v[236:237], v50 offset:36096
    ds_read_b64_tr_b16 v[238:239], v50 offset:38656
    buffer_load_dwordx4 v47, s[24:27], s49 offen offset:3072 lds
    s_waitcnt lgkmcnt(10)
    v_mfma_f32_32x32x16_bf16 v[128:143], v[216:219], v[192:195], v[128:143]
    s_add_u32 m0, s41, 4096
    s_nop 0
    buffer_load_dwordx4 v48, s[24:27], s49 offen offset:0 lds
    s_waitcnt lgkmcnt(8)
    v_mfma_f32_32x32x16_bf16 v[64:79], v[220:223], v[196:199], v[64:79]
    s_waitcnt lgkmcnt(6)
    v_mfma_f32_32x32x16_bf16 v[80:95], v[224:227], v[196:199], v[80:95]
    s_waitcnt lgkmcnt(4)
    v_mfma_f32_32x32x16_bf16 v[96:111], v[228:231], v[196:199], v[96:111]
    s_add_u32 s41, s36, 41
    s_and_b32 s41, s41, 31
    s_mul_i32 s41, s41, 5120
    s_mov_b32 m0, s41
    s_add_u32 s49, s55, 81920
    buffer_load_dwordx4 v44, s[24:27], s49 offen offset:0 lds
    s_waitcnt lgkmcnt(2)
    v_mfma_f32_32x32x16_bf16 v[112:127], v[232:235], v[196:199], v[112:127]
    buffer_load_dwordx4 v45, s[24:27], s49 offen offset:1024 lds
    s_waitcnt lgkmcnt(0)
    v_mfma_f32_32x32x16_bf16 v[128:143], v[236:239], v[196:199], v[128:143]
    buffer_load_dwordx4 v46, s[24:27], s49 offen offset:2048 lds
    buffer_load_dwordx4 v47, s[24:27], s49 offen offset:3072 lds
    s_add_u32 m0, s41, 4096
    s_nop 0
    buffer_load_dwordx4 v48, s[24:27], s49 offen offset:0 lds
    v_bfe_u32 v8, v1, 4, 1
    v_mul_u32_u24 v8, 40960, v8
    v_and_b32 v9, 15, v1
    v_lshrrev_b32 v11, 5, v1
    v_lshl_add_u32 v2, v11, 4, v9
    v_lshl_add_u32 v2, v2, 4, v8
    s_lshl_b32 s41, s38, 2
    s_add_u32 s41, s41, s39
    s_lshl_b32 s59, s41, 3
    s_lshl_b32 s42, s36, 1
    s_add_u32 s42, s59, s42
    s_lshl_b32 s42, s42, 3
    s_add_u32 s42, s42, s37
    s_mul_i32 s42, s42, 5120
    s_add_u32 s4, s42, 0x1000000
    s_add_u32 s5, s4, 4096
    s_lshl_b32 s41, s41, 2
    s_add_u32 s44, s41, s36
    s_lshl_b32 s44, s44, 3
    s_add_u32 s44, s44, s37
    s_lshl_b32 s44, s44, 7
    s_add_u32 s44, s44, 0x2040000
    v_mov_b32 v6, s44
    s_lshr_b32 s44, s37, 1
    s_add_u32 s44, s41, s44
    s_lshl_b32 s44, s44, 10
    s_add_u32 s44, s44, 0x2040000
    s_lshr_b32 s43, s36, 1
    s_lshl_b32 s43, s43, 17
    s_add_u32 s44, s44, s43
    v_and_b32 v8, 7, v1
    v_lshlrev_b32 v8, 7, v8
    v_add_u32 v5, s44, v8
    v_mov_b32 v7, s57
    v_mul_u32_u24 v8, 5120, v11
    v_and_b32 v9, 31, v1
    v_lshl_add_u32 v3, v9, 4, v8
    s_add_u32 s41, s59, s37
    s_mul_i32 s41, s41, 40960
    s_add_u32 s41, s41, 0x1000000
    s_mul_i32 s42, s36, 3
    s_cmp_eq_u32 s36, 3
    s_cselect_b32 s42, 8, s42
    s_lshl_b32 s43, s42, 9
    s_add_u32 s6, s41, s43
    v_and_b32 v8, 15, v1
    v_mul_u32_u24 v8, 1280, v8
    v_bfe_u32 v9, v1, 4, 1
    v_lshl_add_u32 v8, v9, 3, v8
    v_lshl_add_u32 v4, v11, 4, v8
    s_lshl_b32 s43, s38, 3
    s_add_u32 s43, s43, s37
    s_mul_i32 s43, s43, 20480
    s_mul_i32 s44, s39, 320
    s_add_u32 s43, s43, s44
    s_lshl_b32 s42, s42, 5
    s_add_u32 s7, s43, s42
    s_waitcnt vmcnt(0)
    s_barrier
    s_mov_b64 exec, 0xf
    s_mov_b32 s60, 0
L_poll1:
    buffer_load_dword v10, v58, s[32:35], 0 offen sc1
    s_waitcnt vmcnt(0)
    v_cmp_ne_u32 vcc, s56, v10
    s_add_u32 s60, s60, 1
    s_cmp_ge_u32 s60, 0x100000
    s_cbranch_scc1 L_poll1_done
    s_cbranch_vccnz L_poll1
L_poll1_done:
    s_mov_b64 exec, -1
    s_or_b32 s41, s39, s36
    s_cmp_lg_u32 s41, 0
    s_cbranch_scc1 L_noe1
    s_lshr_b32 s41, s58, 17
    s_lshl_b32 s41, s41, 7
    s_add_u32 s41, s41, 0x2000000
    v_mov_b32 v8, s41
    s_mov_b64 exec, 1
    buffer_store_dword v60, v8, s[32:35], 0 offen sc1
    s_mov_b64 exec, -1
L_noe1:
    s_add_u32 s41, s39, 1
    s_and_b32 s41, s41, 3
    s_lshl_b32 s41, s41, 13
    s_add_u32 s90, s41, s58
    s_add_u32 s91, s90, 4096
    s_add_u32 s41, s39, 2
    s_and_b32 s41, s41, 3
    s_lshl_b32 s41, s41, 13
    s_add_u32 s92, s41, s58
    s_add_u32 s93, s92, 4096
    s_add_u32 s41, s39, 3
    s_and_b32 s41, s41, 3
    s_lshl_b32 s41, s41, 13
    s_add_u32 s94, s41, s58
    s_add_u32 s95, s94, 4096
    buffer_load_dwordx4 v[168:171], v30, s[32:35], s90 offen offset:0 sc1
    buffer_load_dwordx4 v[172:175], v30, s[32:35], s90 offen offset:1024 sc1
    buffer_load_dwordx4 v[176:179], v30, s[32:35], s90 offen offset:2048 sc1
    buffer_load_dwordx4 v[180:183], v30, s[32:35], s90 offen offset:3072 sc1
    buffer_load_dwordx4 v[184:187], v30, s[32:35], s91 offen offset:0 sc1
    buffer_load_dwordx4 v[188:191], v30, s[32:35], s91 offen offset:1024 sc1
    buffer_load_dwordx4 v[192:195], v30, s[32:35], s91 offen offset:2048 sc1
    buffer_load_dwordx4 v[196:199], v30, s[32:35], s91 offen offset:3072 sc1
    ds_read_b64_tr_b16 v[200:201], v50 offset:40960
    ds_read_b64_tr_b16 v[202:203], v50 offset:43520
    ds_read_b64_tr_b16 v[204:205], v50 offset:41024
    ds_read_b64_tr_b16 v[206:207], v50 offset:43584
    ds_read_b64_tr_b16 v[208:209], v50 offset:41088
    ds_read_b64_tr_b16 v[210:211], v50 offset:43648
    ds_read_b64_tr_b16 v[212:213], v50 offset:41152
    ds_read_b64_tr_b16 v[214:215], v50 offset:43712
    ds_read_b64_tr_b16 v[216:217], v50 offset:41216
    ds_read_b64_tr_b16 v[218:219], v50 offset:43776
    s_waitcnt vmcnt(7)
    s_waitcnt lgkmcnt(8)
    v_mfma_f32_32x32x16_bf16 v[64:79], v[200:203], v[168:171], v[64:79]
    ds_read_b64_tr_b16 v[220:221], v50 offset:46080
    ds_read_b64_tr_b16 v[222:223], v50 offset:48640
    ds_read_b64_tr_b16 v[224:225], v50 offset:46144
    s_waitcnt lgkmcnt(9)
    v_mfma_f32_32x32x16_bf16 v[80:95], v[204:207], v[168:171], v[80:95]
    ds_read_b64_tr_b16 v[226:227], v50 offset:48704
    ds_read_b64_tr_b16 v[228:229], v50 offset:46208
    ds_read_b64_tr_b16 v[230:231], v50 offset:48768
    s_waitcnt lgkmcnt(10)
    v_mfma_f32_32x32x16_bf16 v[96:111], v[208:211], v[168:171], v[96:111]
    ds_read_b64_tr_b16 v[232:233], v50 offset:46272
    ds_read_b64_tr_b16 v[234:235], v50 offset:48832
    buffer_load_dwordx4 v[144:147], v30, s[32:35], s92 offen offset:0 sc1
    s_waitcnt lgkmcnt(10)
    v_mfma_f32_32x32x16_bf16 v[112:127], v[212:215], v[168:171], v[112:127]
    ds_read_b64_tr_b16 v[236:237], v50 offset:46336
    ds_read_b64_tr_b16 v[238:239], v50 offset:48896
    buffer_load_dwordx4 v[148:151], v30, s[32:35], s92 offen offset:1024 sc1
    s_waitcnt lgkmcnt(10)
    v_mfma_f32_32x32x16_bf16 v[128:143], v[216:219], v[168:171], v[128:143]
    buffer_load_dwordx4 v[152:155], v30, s[32:35], s92 offen offset:2048 sc1
    s_waitcnt vmcnt(9)
    s_waitcnt lgkmcnt(8)
    v_mfma_f32_32x32x16_bf16 v[64:79], v[220:223], v[172:175], v[64:79]
    ds_read_b64_tr_b16 v[200:201], v50 offset:51200
    ds_read_b64_tr_b16 v[202:203], v50 offset:53760
    ds_read_b64_tr_b16 v[204:205], v50 offset:51264
    s_waitcnt lgkmcnt(9)
    v_mfma_f32_32x32x16_bf16 v[80:95], v[224:227], v[172:175], v[80:95]
    ds_read_b64_tr_b16 v[206:207], v50 offset:53824
    ds_read_b64_tr_b16 v[208:209], v50 offset:51328
    ds_read_b64_tr_b16 v[210:211], v50 offset:53888
    s_waitcnt lgkmcnt(10)
    v_mfma_f32_32x32x16_bf16 v[96:111], v[228:231], v[172:175], v[96:111]
    ds_read_b64_tr_b16 v[212:213], v50 offset:51392
    ds_read_b64_tr_b16 v[214:215], v50 offset:53952
    buffer_load_dwordx4 v[156:159], v30, s[32:35], s92 offen offset:3072 sc1
    s_waitcnt lgkmcnt(10)
    v_mfma_f32_32x32x16_bf16 v[112:127], v[232:235], v[172:175], v[112:127]
    ds_read_b64_tr_b16 v[216:217], v50 offset:51456
    ds_read_b64_tr_b16 v[218:219], v50 offset:54016
    buffer_load_dwordx4 v[160:163], v30, s[32:35], s93 offen offset:0 sc1
    s_waitcnt lgkmcnt(10)
    v_mfma_f32_32x32x16_bf16 v[128:143], v[236:239], v[172:175], v[128:143]
    buffer_load_dwordx4 v[164:167], v30, s[32:35], s93 offen offset:1024 sc1
    s_waitcnt vmcnt(11)
    s_waitcnt lgkmcnt(8)
    v_mfma_f32_32x32x16_bf16 v[64:79], v[200:203], v[176:179], v[64:79]
    ds_read_b64_tr_b16 v[220:221], v50 offset:56320
    ds_read_b64_tr_b16 v[222:223], v50 offset:58880
    ds_read_b64_tr_b16 v[224:225], v50 offset:56384
    s_waitcnt lgkmcnt(9)
    v_mfma_f32_32x32x16_bf16 v[80:95], v[204:207], v[176:179], v[80:95]
    ds_read_b64_tr_b16 v[226:227], v50 offset:58944
    ds_read_b64_tr_b16 v[228:229], v50 offset:56448
    ds_read_b64_tr_b16 v[230:231], v50 offset:59008
    s_waitcnt lgkmcnt(10)
    v_mfma_f32_32x32x16_bf16 v[96:111], v[208:211], v[176:179], v[96:111]
    ds_read_b64_tr_b16 v[232:233], v50 offset:56512
    ds_read_b64_tr_b16 v[234:235], v50 offset:59072
    buffer_load_dwordx4 v[240:243], v30, s[32:35], s93 offen offset:2048 sc1
    s_waitcnt lgkmcnt(10)
    v_mfma_f32_32x32x16_bf16 v[112:127], v[212:215], v[176:179], v[112:127]
    ds_read_b64_tr_b16 v[236:237], v50 offset:56576
    ds_read_b64_tr_b16 v[238:239], v50 offset:59136
    buffer_load_dwordx4 v[244:247], v30, s[32:35], s93 offen offset:3072 sc1
    s_waitcnt lgkmcnt(10)
    v_mfma_f32_32x32x16_bf16 v[128:143], v[216:219], v[176:179], v[128:143]
    buffer_load_dwordx4 v[248:251], v30, s[32:35], s94 offen offset:0 sc1
    s_waitcnt vmcnt(13)
    s_waitcnt lgkmcnt(8)
    v_mfma_f32_32x32x16_bf16 v[64:79], v[220:223], v[180:183], v[64:79]
    ds_read_b64_tr_b16 v[200:201], v51 offset:0
    ds_read_b64_tr_b16 v[202:203], v51 offset:2560
    ds_read_b64_tr_b16 v[204:205], v51 offset:64
    s_waitcnt lgkmcnt(9)
    v_mfma_f32_32x32x16_bf16 v[80:95], v[224:227], v[180:183], v[80:95]
    ds_read_b64_tr_b16 v[206:207], v51 offset:2624
    ds_read_b64_tr_b16 v[208:209], v51 offset:128
    ds_read_b64_tr_b16 v[210:211], v51 offset:2688
    s_waitcnt lgkmcnt(10)
    v_mfma_f32_32x32x16_bf16 v[96:111], v[228:231], v[180:183], v[96:111]
    ds_read_b64_tr_b16 v[212:213], v51 offset:192
    ds_read_b64_tr_b16 v[214:215], v51 offset:2752
    buffer_load_dwordx4 v[252:255], v30, s[32:35], s94 offen offset:1024 sc1
    s_waitcnt lgkmcnt(10)
    v_mfma_f32_32x32x16_bf16 v[112:127], v[232:235], v[180:183], v[112:127]
    ds_read_b64_tr_b16 v[216:217], v51 offset:256
    ds_read_b64_tr_b16 v[218:219], v51 offset:2816
    buffer_load_dwordx4 v[16:19], v30, s[32:35], s94 offen offset:2048 sc1
    s_waitcnt lgkmcnt(10)
    v_mfma_f32_32x32x16_bf16 v[128:143], v[236:239], v[180:183], v[128:143]
    buffer_load_dwordx4 v[20:23], v30, s[32:35], s94 offen offset:3072 sc1
    s_waitcnt vmcnt(15)
    s_waitcnt lgkmcnt(8)
    v_mfma_f32_32x32x16_bf16 v[64:79], v[200:203], v[184:187], v[64:79]
    ds_read_b64_tr_b16 v[220:221], v51 offset:5120
    ds_read_b64_tr_b16 v[222:223], v51 offset:7680
    ds_read_b64_tr_b16 v[224:225], v51 offset:5184
    s_waitcnt lgkmcnt(9)
    v_mfma_f32_32x32x16_bf16 v[80:95], v[204:207], v[184:187], v[80:95]
    ds_read_b64_tr_b16 v[226:227], v51 offset:7744
    ds_read_b64_tr_b16 v[228:229], v51 offset:5248
    ds_read_b64_tr_b16 v[230:231], v51 offset:7808
    s_waitcnt lgkmcnt(10)
    v_mfma_f32_32x32x16_bf16 v[96:111], v[208:211], v[184:187], v[96:111]
    ds_read_b64_tr_b16 v[232:233], v51 offset:5312
    ds_read_b64_tr_b16 v[234:235], v51 offset:7872
    buffer_load_dwordx4 v[24:27], v30, s[32:35], s95 offen offset:0 sc1
    s_waitcnt lgkmcnt(10)
    v_mfma_f32_32x32x16_bf16 v[112:127], v[212:215], v[184:187], v[112:127]
    ds_read_b64_tr_b16 v[236:237], v51 offset:5376
    ds_read_b64_tr_b16 v[238:239], v51 offset:7936
    buffer_load_dwordx4 v[32:35], v30, s[32:35], s95 offen offset:1024 sc1
    s_waitcnt lgkmcnt(10)
    v_mfma_f32_32x32x16_bf16 v[128:143], v[216:219], v[184:187], v[128:143]
    buffer_load_dwordx4 v[36:39], v30, s[32:35], s95 offen offset:2048 sc1
    s_waitcnt vmcnt(17)
    s_waitcnt lgkmcnt(8)
    v_mfma_f32_32x32x16_bf16 v[64:79], v[220:223], v[188:191], v[64:79]
    ds_read_b64_tr_b16 v[200:201], v51 offset:10240
    ds_read_b64_tr_b16 v[202:203], v51 offset:12800
    ds_read_b64_tr_b16 v[204:205], v51 offset:10304
    s_waitcnt lgkmcnt(9)
    v_mfma_f32_32x32x16_bf16 v[80:95], v[224:227], v[188:191], v[80:95]
    ds_read_b64_tr_b16 v[206:207], v51 offset:12864
    ds_read_b64_tr_b16 v[208:209], v51 offset:10368
    ds_read_b64_tr_b16 v[210:211], v51 offset:12928
    s_waitcnt lgkmcnt(10)
    v_mfma_f32_32x32x16_bf16 v[96:111], v[228:231], v[188:191], v[96:111]
    ds_read_b64_tr_b16 v[212:213], v51 offset:10432
    ds_read_b64_tr_b16 v[214:215], v51 offset:12992
    buffer_load_dwordx4 v[40:43], v30, s[32:35], s95 offen offset:3072 sc1
    s_waitcnt lgkmcnt(10)
    v_mfma_f32_32x32x16_bf16 v[112:127], v[232:235], v[188:191], v[112:127]
    ds_read_b64_tr_b16 v[216:217], v51 offset:10496
    ds_read_b64_tr_b16 v[218:219], v51 offset:13056
    s_waitcnt lgkmcnt(10)
    v_mfma_f32_32x32x16_bf16 v[128:143], v[236:239], v[188:191], v[128:143]
    s_waitcnt vmcnt(17)
    s_waitcnt lgkmcnt(8)
    v_mfma_f32_32x32x16_bf16 v[64:79], v[200:203], v[192:195], v[64:79]
    ds_read_b64_tr_b16 v[220:221], v51 offset:15360
    ds_read_b64_tr_b16 v[222:223], v51 offset:17920
    ds_read_b64_tr_b16 v[224:225], v51 offset:15424
    s_waitcnt lgkmcnt(9)
    v_mfma_f32_32x32x16_bf16 v[80:95], v[204:207], v[192:195], v[80:95]
    ds_read_b64_tr_b16 v[226:227], v51 offset:17984
    ds_read_b64_tr_b16 v[228:229], v51 offset:15488
    ds_read_b64_tr_b16 v[230:231], v51 offset:18048
    s_waitcnt lgkmcnt(10)
    v_mfma_f32_32x32x16_bf16 v[96:111], v[208:211], v[192:195], v[96:111]
    ds_read_b64_tr_b16 v[232:233], v51 offset:15552
    ds_read_b64_tr_b16 v[234:235], v51 offset:18112
    s_waitcnt lgkmcnt(10)
    v_mfma_f32_32x32x16_bf16 v[112:127], v[212:215], v[192:195], v[112:127]
    ds_read_b64_tr_b16 v[236:237], v51 offset:15616
    ds_read_b64_tr_b16 v[238:239], v51 offset:18176
    s_waitcnt lgkmcnt(10)
    v_mfma_f32_32x32x16_bf16 v[128:143], v[216:219], v[192:195], v[128:143]
    s_waitcnt vmcnt(16)
    s_waitcnt lgkmcnt(8)
    v_mfma_f32_32x32x16_bf16 v[64:79], v[220:223], v[196:199], v[64:79]
    ds_read_b64_tr_b16 v[200:201], v51 offset:20480
    ds_read_b64_tr_b16 v[202:203], v51 offset:23040
    ds_read_b64_tr_b16 v[204:205], v51 offset:25600
    s_waitcnt lgkmcnt(9)
    v_mfma_f32_32x32x16_bf16 v[80:95], v[224:227], v[196:199], v[80:95]
    ds_read_b64_tr_b16 v[206:207], v51 offset:28160
    ds_read_b64_tr_b16 v[208:209], v51 offset:30720
    ds_read_b64_tr_b16 v[210:211], v51 offset:33280
    s_waitcnt lgkmcnt(10)
    v_mfma_f32_32x32x16_bf16 v[96:111], v[228:231], v[196:199], v[96:111]
    ds_read_b64_tr_b16 v[212:213], v49 offset:0
    ds_read_b64_tr_b16 v[214:215], v49 offset:2560
    s_waitcnt lgkmcnt(10)
    v_mfma_f32_32x32x16_bf16 v[112:127], v[232:235], v[196:199], v[112:127]
    ds_read_b64_tr_b16 v[216:217], v49 offset:5120
    ds_read_b64_tr_b16 v[218:219], v49 offset:7680
    s_waitcnt lgkmcnt(10)
    v_mfma_f32_32x32x16_bf16 v[128:143], v[236:239], v[196:199], v[128:143]
    s_waitcnt vmcnt(15)
    s_waitcnt lgkmcnt(8)
    v_mfma_f32_32x32x16_bf16 v[64:79], v[200:203], v[144:147], v[64:79]
    ds_read_b64_tr_b16 v[220:221], v49 offset:10240
    ds_read_b64_tr_b16 v[222:223], v49 offset:12800
    s_waitcnt vmcnt(14)
    s_waitcnt lgkmcnt(8)
    v_mfma_f32_32x32x16_bf16 v[64:79], v[204:207], v[148:151], v[64:79]
    ds_read_b64_tr_b16 v[224:225], v49 offset:15360
    ds_read_b64_tr_b16 v[226:227], v49 offset:17920
    s_waitcnt vmcnt(13)
    s_waitcnt lgkmcnt(8)
    v_mfma_f32_32x32x16_bf16 v[64:79], v[208:211], v[152:155], v[64:79]
    ds_read_b64_tr_b16 v[228:229], v49 offset:20480
    ds_read_b64_tr_b16 v[230:231], v49 offset:23040
    s_waitcnt vmcnt(12)
    s_waitcnt lgkmcnt(8)
    v_mfma_f32_32x32x16_bf16 v[64:79], v[212:215], v[156:159], v[64:79]
    ds_read_b64_tr_b16 v[232:233], v49 offset:25600
    ds_read_b64_tr_b16 v[234:235], v49 offset:28160
    s_waitcnt vmcnt(11)
    s_waitcnt lgkmcnt(8)
    v_mfma_f32_32x32x16_bf16 v[64:79], v[216:219], v[160:163], v[64:79]
    ds_read_b64_tr_b16 v[236:237], v49 offset:30720
    ds_read_b64_tr_b16 v[238:239], v49 offset:33280
    s_waitcnt vmcnt(10)
    s_waitcnt lgkmcnt(8)
    v_mfma_f32_32x32x16_bf16 v[64:79], v[220:223], v[164:167], v[64:79]
    ds_read_b64_tr_b16 v[200:201], v49 offset:35840
    ds_read_b64_tr_b16 v[202:203], v49 offset:38400
    s_waitcnt vmcnt(9)
    s_waitcnt lgkmcnt(8)
    v_mfma_f32_32x32x16_bf16 v[64:79], v[224:227], v[240:243], v[64:79]
    ds_read_b64_tr_b16 v[204:205], v49 offset:40960
    ds_read_b64_tr_b16 v[206:207], v49 offset:43520
    s_waitcnt vmcnt(8)
    s_waitcnt lgkmcnt(8)
    v_mfma_f32_32x32x16_bf16 v[64:79], v[228:231], v[244:247], v[64:79]
    ds_read_b64_tr_b16 v[208:209], v49 offset:46080
    ds_read_b64_tr_b16 v[210:211], v49 offset:48640
    s_waitcnt vmcnt(7)
    s_waitcnt lgkmcnt(8)
    v_mfma_f32_32x32x16_bf16 v[64:79], v[232:235], v[248:251], v[64:79]
    ds_read_b64_tr_b16 v[212:213], v49 offset:51200
    ds_read_b64_tr_b16 v[214:215], v49 offset:53760
    s_waitcnt vmcnt(6)
    s_waitcnt lgkmcnt(8)
    v_mfma_f32_32x32x16_bf16 v[64:79], v[236:239], v[252:255], v[64:79]
    ds_read_b64_tr_b16 v[216:217], v49 offset:56320
    ds_read_b64_tr_b16 v[218:219], v49 offset:58880
    s_waitcnt vmcnt(5)
    s_waitcnt lgkmcnt(8)
    v_mfma_f32_32x32x16_bf16 v[64:79], v[200:203], v[16:19], v[64:79]
    ds_read_b64_tr_b16 v[220:221], v49 offset:61440
    ds_read_b64_tr_b16 v[222:223], v49 offset:64000
    s_waitcnt vmcnt(4)
    s_waitcnt lgkmcnt(8)
    v_mfma_f32_32x32x16_bf16 v[64:79], v[204:207], v[20:23], v[64:79]
    ds_read_b64_tr_b16 v[224:225], v51 offset:20544
    ds_read_b64_tr_b16 v[226:227], v51 offset:23104
    s_waitcnt vmcnt(3)
    s_waitcnt lgkmcnt(8)
    v_mfma_f32_32x32x16_bf16 v[64:79], v[208:211], v[24:27], v[64:79]
    ds_read_b64_tr_b16 v[228:229], v51 offset:25664
    ds_read_b64_tr_b16 v[230:231], v51 offset:28224
    s_waitcnt vmcnt(2)
    s_waitcnt lgkmcnt(8)
    v_mfma_f32_32x32x16_bf16 v[64:79], v[212:215], v[32:35], v[64:79]
    ds_read_b64_tr_b16 v[232:233], v51 offset:30784
    ds_read_b64_tr_b16 v[234:235], v51 offset:33344
    s_waitcnt vmcnt(1)
    s_waitcnt lgkmcnt(8)
    v_mfma_f32_32x32x16_bf16 v[64:79], v[216:219], v[36:39], v[64:79]
    ds_read_b64_tr_b16 v[236:237], v49 offset:64
    ds_read_b64_tr_b16 v[238:239], v49 offset:2624
    s_waitcnt vmcnt(0)
    s_waitcnt lgkmcnt(8)
    v_mfma_f32_32x32x16_bf16 v[64:79], v[220:223], v[40:43], v[64:79]
    ds_read_b64_tr_b16 v[200:201], v49 offset:5184
    ds_read_b64_tr_b16 v[202:203], v49 offset:7744
    s_waitcnt lgkmcnt(8)
    v_mfma_f32_32x32x16_bf16 v[80:95], v[224:227], v[144:147], v[80:95]
    ds_read_b64_tr_b16 v[204:205], v49 offset:10304
    ds_read_b64_tr_b16 v[206:207], v49 offset:12864
    s_waitcnt lgkmcnt(8)
    v_mfma_f32_32x32x16_bf16 v[80:95], v[228:231], v[148:151], v[80:95]
    ds_read_b64_tr_b16 v[208:209], v49 offset:15424
    ds_read_b64_tr_b16 v[210:211], v49 offset:17984
    s_waitcnt lgkmcnt(8)
    v_mfma_f32_32x32x16_bf16 v[80:95], v[232:235], v[152:155], v[80:95]
    ds_read_b64_tr_b16 v[212:213], v49 offset:20544
    ds_read_b64_tr_b16 v[214:215], v49 offset:23104
    s_waitcnt lgkmcnt(8)
    v_mfma_f32_32x32x16_bf16 v[80:95], v[236:239], v[156:159], v[80:95]
    ds_read_b64_tr_b16 v[216:217], v49 offset:25664
    ds_read_b64_tr_b16 v[218:219], v49 offset:28224
    s_waitcnt lgkmcnt(8)
    v_mfma_f32_32x32x16_bf16 v[80:95], v[200:203], v[160:163], v[80:95]
    ds_read_b64_tr_b16 v[220:221], v49 offset:30784
    ds_read_b64_tr_b16 v[222:223], v49 offset:33344
    v_cvt_pk_bf16_f32 v168, v64, v65
    v_cvt_pk_bf16_f32 v169, v66, v67
    v_cvt_pk_bf16_f32 v170, v68, v69
    v_cvt_pk_bf16_f32 v171, v70, v71
    buffer_store_dwordx4 v[168:171], v2, s[32:35], s4 offen offset:0 sc1
    s_waitcnt lgkmcnt(8)
    v_mfma_f32_32x32x16_bf16 v[80:95], v[204:207], v[164:167], v[80:95]
    ds_read_b64_tr_b16 v[224:225], v49 offset:35904
    ds_read_b64_tr_b16 v[226:227], v49 offset:38464
    s_waitcnt lgkmcnt(8)
    v_mfma_f32_32x32x16_bf16 v[80:95], v[208:211], v[240:243], v[80:95]
    ds_read_b64_tr_b16 v[228:229], v49 offset:41024
    ds_read_b64_tr_b16 v[230:231], v49 offset:43584
    s_waitcnt lgkmcnt(8)
    v_mfma_f32_32x32x16_bf16 v[80:95], v[212:215], v[244:247], v[80:95]
    ds_read_b64_tr_b16 v[232:233], v49 offset:46144
    ds_read_b64_tr_b16 v[234:235], v49 offset:48704
    s_waitcnt lgkmcnt(8)
    v_mfma_f32_32x32x16_bf16 v[80:95], v[216:219], v[248:251], v[80:95]
    ds_read_b64_tr_b16 v[236:237], v49 offset:51264
    ds_read_b64_tr_b16 v[238:239], v49 offset:53824
    v_cvt_pk_bf16_f32 v172, v72, v73
    v_cvt_pk_bf16_f32 v173, v74, v75
    v_cvt_pk_bf16_f32 v174, v76, v77
    v_cvt_pk_bf16_f32 v175, v78, v79
    buffer_store_dwordx4 v[172:175], v2, s[32:35], s4 offen offset:512 sc1
    s_waitcnt lgkmcnt(8)
    v_mfma_f32_32x32x16_bf16 v[80:95], v[220:223], v[252:255], v[80:95]
    ds_read_b64_tr_b16 v[200:201], v49 offset:56384
    ds_read_b64_tr_b16 v[202:203], v49 offset:58944
    s_waitcnt lgkmcnt(8)
    v_mfma_f32_32x32x16_bf16 v[80:95], v[224:227], v[16:19], v[80:95]
    ds_read_b64_tr_b16 v[204:205], v49 offset:61504
    ds_read_b64_tr_b16 v[206:207], v49 offset:64064
    s_waitcnt lgkmcnt(8)
    v_mfma_f32_32x32x16_bf16 v[80:95], v[228:231], v[20:23], v[80:95]
    ds_read_b64_tr_b16 v[208:209], v51 offset:20608
    ds_read_b64_tr_b16 v[210:211], v51 offset:23168
    s_waitcnt lgkmcnt(8)
    v_mfma_f32_32x32x16_bf16 v[80:95], v[232:235], v[24:27], v[80:95]
    ds_read_b64_tr_b16 v[212:213], v51 offset:25728
    ds_read_b64_tr_b16 v[214:215], v51 offset:28288
    s_waitcnt lgkmcnt(8)
    v_mfma_f32_32x32x16_bf16 v[80:95], v[236:239], v[32:35], v[80:95]
    ds_read_b64_tr_b16 v[216:217], v51 offset:30848
    ds_read_b64_tr_b16 v[218:219], v51 offset:33408
    s_waitcnt lgkmcnt(8)
    v_mfma_f32_32x32x16_bf16 v[80:95], v[200:203], v[36:39], v[80:95]
    ds_read_b64_tr_b16 v[220:221], v49 offset:128
    ds_read_b64_tr_b16 v[222:223], v49 offset:2688
    s_waitcnt lgkmcnt(8)
    v_mfma_f32_32x32x16_bf16 v[80:95], v[204:207], v[40:43], v[80:95]
    ds_read_b64_tr_b16 v[224:225], v49 offset:5248
    ds_read_b64_tr_b16 v[226:227], v49 offset:7808
    s_waitcnt lgkmcnt(8)
    v_mfma_f32_32x32x16_bf16 v[96:111], v[208:211], v[144:147], v[96:111]
    ds_read_b64_tr_b16 v[228:229], v49 offset:10368
    ds_read_b64_tr_b16 v[230:231], v49 offset:12928
    s_waitcnt lgkmcnt(8)
    v_mfma_f32_32x32x16_bf16 v[96:111], v[212:215], v[148:151], v[96:111]
    ds_read_b64_tr_b16 v[232:233], v49 offset:15488
    ds_read_b64_tr_b16 v[234:235], v49 offset:18048
    s_waitcnt lgkmcnt(8)
    v_mfma_f32_32x32x16_bf16 v[96:111], v[216:219], v[152:155], v[96:111]
    ds_read_b64_tr_b16 v[236:237], v49 offset:20608
    ds_read_b64_tr_b16 v[238:239], v49 offset:23168
    s_waitcnt lgkmcnt(8)
    v_mfma_f32_32x32x16_bf16 v[96:111], v[220:223], v[156:159], v[96:111]
    ds_read_b64_tr_b16 v[200:201], v49 offset:25728
    ds_read_b64_tr_b16 v[202:203], v49 offset:28288
    s_waitcnt lgkmcnt(8)
    v_mfma_f32_32x32x16_bf16 v[96:111], v[224:227], v[160:163], v[96:111]
    ds_read_b64_tr_b16 v[204:205], v49 offset:30848
    ds_read_b64_tr_b16 v[206:207], v49 offset:33408
    v_cvt_pk_bf16_f32 v176, v80, v81
    v_cvt_pk_bf16_f32 v177, v82, v83
    v_cvt_pk_bf16_f32 v178, v84, v85
    v_cvt_pk_bf16_f32 v179, v86, v87
    buffer_store_dwordx4 v[176:179], v2, s[32:35], s4 offen offset:1024 sc1
    s_waitcnt lgkmcnt(8)
    v_mfma_f32_32x32x16_bf16 v[96:111], v[228:231], v[164:167], v[96:111]
    ds_read_b64_tr_b16 v[208:209], v49 offset:35968
    ds_read_b64_tr_b16 v[210:211], v49 offset:38528
    s_waitcnt lgkmcnt(8)
    v_mfma_f32_32x32x16_bf16 v[96:111], v[232:235], v[240:243], v[96:111]
    ds_read_b64_tr_b16 v[212:213], v49 offset:41088
    ds_read_b64_tr_b16 v[214:215], v49 offset:43648
    s_waitcnt lgkmcnt(8)
    v_mfma_f32_32x32x16_bf16 v[96:111], v[236:239], v[244:247], v[96:111]
    ds_read_b64_tr_b16 v[216:217], v49 offset:46208
    ds_read_b64_tr_b16 v[218:219], v49 offset:48768
    s_waitcnt lgkmcnt(8)
    v_mfma_f32_32x32x16_bf16 v[96:111], v[200:203], v[248:251], v[96:111]
    ds_read_b64_tr_b16 v[220:221], v49 offset:51328
    ds_read_b64_tr_b16 v[222:223], v49 offset:53888
    v_cvt_pk_bf16_f32 v180, v88, v89
    v_cvt_pk_bf16_f32 v181, v90, v91
    v_cvt_pk_bf16_f32 v182, v92, v93
    v_cvt_pk_bf16_f32 v183, v94, v95
    buffer_store_dwordx4 v[180:183], v2, s[32:35], s4 offen offset:1536 sc1
    s_waitcnt lgkmcnt(8)
    v_mfma_f32_32x32x16_bf16 v[96:111], v[204:207], v[252:255], v[96:111]
    ds_read_b64_tr_b16 v[224:225], v49 offset:56448
    ds_read_b64_tr_b16 v[226:227], v49 offset:59008
    s_waitcnt lgkmcnt(8)
    v_mfma_f32_32x32x16_bf16 v[96:111], v[208:211], v[16:19], v[96:111]
    ds_read_b64_tr_b16 v[228:229], v49 offset:61568
    ds_read_b64_tr_b16 v[230:231], v49 offset:64128
    s_waitcnt lgkmcnt(8)
    v_mfma_f32_32x32x16_bf16 v[96:111], v[212:215], v[20:23], v[96:111]
    ds_read_b64_tr_b16 v[232:233], v51 offset:20672
    ds_read_b64_tr_b16 v[234:235], v51 offset:23232
    s_waitcnt lgkmcnt(8)
    v_mfma_f32_32x32x16_bf16 v[96:111], v[216:219], v[24:27], v[96:111]
    ds_read_b64_tr_b16 v[236:237], v51 offset:25792
    ds_read_b64_tr_b16 v[238:239], v51 offset:28352
    s_waitcnt lgkmcnt(8)
    v_mfma_f32_32x32x16_bf16 v[96:111], v[220:223], v[32:35], v[96:111]
    ds_read_b64_tr_b16 v[200:201], v51 offset:30912
    ds_read_b64_tr_b16 v[202:203], v51 offset:33472
    s_waitcnt lgkmcnt(8)
    v_mfma_f32_32x32x16_bf16 v[96:111], v[224:227], v[36:39], v[96:111]
    ds_read_b64_tr_b16 v[204:205], v49 offset:192
    ds_read_b64_tr_b16 v[206:207], v49 offset:2752
    s_waitcnt lgkmcnt(8)
    v_mfma_f32_32x32x16_bf16 v[96:111], v[228:231], v[40:43], v[96:111]
    ds_read_b64_tr_b16 v[208:209], v49 offset:5312
    ds_read_b64_tr_b16 v[210:211], v49 offset:7872
    s_waitcnt lgkmcnt(8)
    v_mfma_f32_32x32x16_bf16 v[112:127], v[232:235], v[144:147], v[112:127]
    ds_read_b64_tr_b16 v[212:213], v49 offset:10432
    ds_read_b64_tr_b16 v[214:215], v49 offset:12992
    s_waitcnt lgkmcnt(8)
    v_mfma_f32_32x32x16_bf16 v[112:127], v[236:239], v[148:151], v[112:127]
    ds_read_b64_tr_b16 v[216:217], v49 offset:15552
    ds_read_b64_tr_b16 v[218:219], v49 offset:18112
    s_waitcnt lgkmcnt(8)
    v_mfma_f32_32x32x16_bf16 v[112:127], v[200:203], v[152:155], v[112:127]
    ds_read_b64_tr_b16 v[220:221], v49 offset:20672
    ds_read_b64_tr_b16 v[222:223], v49 offset:23232
    s_waitcnt lgkmcnt(8)
    v_mfma_f32_32x32x16_bf16 v[112:127], v[204:207], v[156:159], v[112:127]
    ds_read_b64_tr_b16 v[224:225], v49 offset:25792
    ds_read_b64_tr_b16 v[226:227], v49 offset:28352
    s_waitcnt lgkmcnt(8)
    v_mfma_f32_32x32x16_bf16 v[112:127], v[208:211], v[160:163], v[112:127]
    ds_read_b64_tr_b16 v[228:229], v49 offset:30912
    ds_read_b64_tr_b16 v[230:231], v49 offset:33472
    v_cvt_pk_bf16_f32 v184, v96, v97
    v_cvt_pk_bf16_f32 v185, v98, v99
    v_cvt_pk_bf16_f32 v186, v100, v101
    v_cvt_pk_bf16_f32 v187, v102, v103
    buffer_store_dwordx4 v[184:187], v2, s[32:35], s4 offen offset:2048 sc1
    s_waitcnt lgkmcnt(8)
    v_mfma_f32_32x32x16_bf16 v[112:127], v[212:215], v[164:167], v[112:127]
    ds_read_b64_tr_b16 v[232:233], v49 offset:36032
    ds_read_b64_tr_b16 v[234:235], v49 offset:38592
    s_waitcnt lgkmcnt(8)
    v_mfma_f32_32x32x16_bf16 v[112:127], v[216:219], v[240:243], v[112:127]
    ds_read_b64_tr_b16 v[236:237], v49 offset:41152
    ds_read_b64_tr_b16 v[238:239], v49 offset:43712
    s_waitcnt lgkmcnt(8)
    v_mfma_f32_32x32x16_bf16 v[112:127], v[220:223], v[244:247], v[112:127]
    ds_read_b64_tr_b16 v[200:201], v49 offset:46272
    ds_read_b64_tr_b16 v[202:203], v49 offset:48832
    s_waitcnt lgkmcnt(8)
    v_mfma_f32_32x32x16_bf16 v[112:127], v[224:227], v[248:251], v[112:127]
    ds_read_b64_tr_b16 v[204:205], v49 offset:51392
    ds_read_b64_tr_b16 v[206:207], v49 offset:53952
    v_cvt_pk_bf16_f32 v188, v104, v105
    v_cvt_pk_bf16_f32 v189, v106, v107
    v_cvt_pk_bf16_f32 v190, v108, v109
    v_cvt_pk_bf16_f32 v191, v110, v111
    buffer_store_dwordx4 v[188:191], v2, s[32:35], s4 offen offset:2560 sc1
    s_waitcnt lgkmcnt(8)
    v_mfma_f32_32x32x16_bf16 v[112:127], v[228:231], v[252:255], v[112:127]
    ds_read_b64_tr_b16 v[208:209], v49 offset:56512
    ds_read_b64_tr_b16 v[210:211], v49 offset:59072
    s_waitcnt lgkmcnt(8)
    v_mfma_f32_32x32x16_bf16 v[112:127], v[232:235], v[16:19], v[112:127]
    ds_read_b64_tr_b16 v[212:213], v49 offset:61632
    ds_read_b64_tr_b16 v[214:215], v49 offset:64192
    s_waitcnt lgkmcnt(8)
    v_mfma_f32_32x32x16_bf16 v[112:127], v[236:239], v[20:23], v[112:127]
    ds_read_b64_tr_b16 v[216:217], v51 offset:20736
    ds_read_b64_tr_b16 v[218:219], v51 offset:23296
    s_waitcnt lgkmcnt(8)
    v_mfma_f32_32x32x16_bf16 v[112:127], v[200:203], v[24:27], v[112:127]
    ds_read_b64_tr_b16 v[220:221], v51 offset:25856
    ds_read_b64_tr_b16 v[222:223], v51 offset:28416
    s_waitcnt lgkmcnt(8)
    v_mfma_f32_32x32x16_bf16 v[112:127], v[204:207], v[32:35], v[112:127]
    ds_read_b64_tr_b16 v[224:225], v51 offset:30976
    ds_read_b64_tr_b16 v[226:227], v51 offset:33536
    s_waitcnt lgkmcnt(8)
    v_mfma_f32_32x32x16_bf16 v[112:127], v[208:211], v[36:39], v[112:127]
    ds_read_b64_tr_b16 v[228:229], v49 offset:256
    ds_read_b64_tr_b16 v[230:231], v49 offset:2816
    s_waitcnt lgkmcnt(8)
    v_mfma_f32_32x32x16_bf16 v[112:127], v[212:215], v[40:43], v[112:127]
    ds_read_b64_tr_b16 v[232:233], v49 offset:5376
    ds_read_b64_tr_b16 v[234:235], v49 offset:7936
    s_waitcnt lgkmcnt(8)
    v_mfma_f32_32x32x16_bf16 v[128:143], v[216:219], v[144:147], v[128:143]
    ds_read_b64_tr_b16 v[236:237], v49 offset:10496
    ds_read_b64_tr_b16 v[238:239], v49 offset:13056
    s_waitcnt lgkmcnt(8)
    v_mfma_f32_32x32x16_bf16 v[128:143], v[220:223], v[148:151], v[128:143]
    ds_read_b64_tr_b16 v[200:201], v49 offset:15616
    ds_read_b64_tr_b16 v[202:203], v49 offset:18176
    s_waitcnt lgkmcnt(8)
    v_mfma_f32_32x32x16_bf16 v[128:143], v[224:227], v[152:155], v[128:143]
    ds_read_b64_tr_b16 v[204:205], v49 offset:20736
    ds_read_b64_tr_b16 v[206:207], v49 offset:23296
    s_waitcnt lgkmcnt(8)
    v_mfma_f32_32x32x16_bf16 v[128:143], v[228:231], v[156:159], v[128:143]
    ds_read_b64_tr_b16 v[208:209], v49 offset:25856
    ds_read_b64_tr_b16 v[210:211], v49 offset:28416
    s_waitcnt lgkmcnt(8)
    v_mfma_f32_32x32x16_bf16 v[128:143], v[232:235], v[160:163], v[128:143]
    ds_read_b64_tr_b16 v[212:213], v49 offset:30976
    ds_read_b64_tr_b16 v[214:215], v49 offset:33536
    v_cvt_pk_bf16_f32 v192, v112, v113
    v_cvt_pk_bf16_f32 v193, v114, v115
    v_cvt_pk_bf16_f32 v194, v116, v117
    v_cvt_pk_bf16_f32 v195, v118, v119
    buffer_store_dwordx4 v[192:195], v2, s[32:35], s4 offen offset:3072 sc1
    s_waitcnt lgkmcnt(8)
    v_mfma_f32_32x32x16_bf16 v[128:143], v[236:239], v[164:167], v[128:143]
    ds_read_b64_tr_b16 v[216:217], v49 offset:36096
    ds_read_b64_tr_b16 v[218:219], v49 offset:38656
    s_waitcnt lgkmcnt(8)
    v_mfma_f32_32x32x16_bf16 v[128:143], v[200:203], v[240:243], v[128:143]
    ds_read_b64_tr_b16 v[220:221], v49 offset:41216
    ds_read_b64_tr_b16 v[222:223], v49 offset:43776
    s_waitcnt lgkmcnt(8)
    v_mfma_f32_32x32x16_bf16 v[128:143], v[204:207], v[244:247], v[128:143]
    ds_read_b64_tr_b16 v[224:225], v49 offset:46336
    ds_read_b64_tr_b16 v[226:227], v49 offset:48896
    s_waitcnt lgkmcnt(8)
    v_mfma_f32_32x32x16_bf16 v[128:143], v[208:211], v[248:251], v[128:143]
    ds_read_b64_tr_b16 v[228:229], v49 offset:51456
    ds_read_b64_tr_b16 v[230:231], v49 offset:54016
    v_cvt_pk_bf16_f32 v196, v120, v121
    v_cvt_pk_bf16_f32 v197, v122, v123
    v_cvt_pk_bf16_f32 v198, v124, v125
    v_cvt_pk_bf16_f32 v199, v126, v127
    buffer_store_dwordx4 v[196:199], v2, s[32:35], s4 offen offset:3584 sc1
    s_waitcnt lgkmcnt(8)
    v_mfma_f32_32x32x16_bf16 v[128:143], v[212:215], v[252:255], v[128:143]
    ds_read_b64_tr_b16 v[232:233], v49 offset:56576
    ds_read_b64_tr_b16 v[234:235], v49 offset:59136
    s_waitcnt lgkmcnt(8)
    v_mfma_f32_32x32x16_bf16 v[128:143], v[216:219], v[16:19], v[128:143]
    ds_read_b64_tr_b16 v[236:237], v49 offset:61696
    ds_read_b64_tr_b16 v[238:239], v49 offset:64256
    s_waitcnt lgkmcnt(8)
    v_mfma_f32_32x32x16_bf16 v[128:143], v[220:223], v[20:23], v[128:143]
    s_waitcnt lgkmcnt(6)
    v_mfma_f32_32x32x16_bf16 v[128:143], v[224:227], v[24:27], v[128:143]
    s_waitcnt lgkmcnt(4)
    v_mfma_f32_32x32x16_bf16 v[128:143], v[228:231], v[32:35], v[128:143]
    s_waitcnt lgkmcnt(2)
    v_mfma_f32_32x32x16_bf16 v[128:143], v[232:235], v[36:39], v[128:143]
    s_waitcnt lgkmcnt(0)
    v_mfma_f32_32x32x16_bf16 v[128:143], v[236:239], v[40:43], v[128:143]
    s_waitcnt vmcnt(2)
    s_mov_b64 exec, 1
    buffer_store_dword v7, v6, s[32:35], 0 offen offset:0 sc1
    s_mov_b64 exec, -1
    s_mov_b32 s44, 0x20000
    s_nop 7
    v_cvt_pk_bf16_f32 v168, v128, v129
    v_cvt_pk_bf16_f32 v169, v130, v131
    v_cvt_pk_bf16_f32 v170, v132, v133
    v_cvt_pk_bf16_f32 v171, v134, v135
    buffer_store_dwordx4 v[168:171], v2, s[32:35], s5 offen offset:0 sc1
    v_cvt_pk_bf16_f32 v172, v136, v137
    v_cvt_pk_bf16_f32 v173, v138, v139
    v_cvt_pk_bf16_f32 v174, v140, v141
    v_cvt_pk_bf16_f32 v175, v142, v143
    buffer_store_dwordx4 v[172:175], v2, s[32:35], s5 offen offset:512 sc1
    s_waitcnt vmcnt(0)
    s_mov_b64 exec, 1
    buffer_store_dword v7, v6, s[32:35], s44 offen sc1
    s_mov_b64 exec, -1
    s_mov_b64 exec, 0xff
    s_mov_b32 s60, 0
L_poll2:
    buffer_load_dword v10, v5, s[32:35], 0 offen sc1
    s_waitcnt vmcnt(0)
    v_cmp_ne_u32 vcc, s57, v10
    s_add_u32 s60, s60, 1
    s_cmp_ge_u32 s60, 0x100000
    s_cbranch_scc1 L_poll2_done
    s_cbranch_vccnz L_poll2
L_poll2_done:
    s_mov_b64 exec, -1
    s_cmp_ge_u32 s36, 2
    s_cbranch_scc1 L_p3_two
    s_add_u32 s49, s6, 0
    buffer_load_dwordx4 v[64:67], v3, s[32:35], s49 offen sc1
    s_add_u32 s49, s6, 10240
    buffer_load_dwordx4 v[68:71], v3, s[32:35], s49 offen sc1
    s_add_u32 s49, s6, 20480
    buffer_load_dwordx4 v[72:75], v3, s[32:35], s49 offen sc1
    s_add_u32 s49, s6, 30720
    buffer_load_dwordx4 v[76:79], v3, s[32:35], s49 offen sc1
    s_add_u32 s49, s6, 512
    buffer_load_dwordx4 v[80:83], v3, s[32:35], s49 offen sc1
    s_add_u32 s49, s6, 10752
    buffer_load_dwordx4 v[84:87], v3, s[32:35], s49 offen sc1
    s_add_u32 s49, s6, 20992
    buffer_load_dwordx4 v[88:91], v3, s[32:35], s49 offen sc1
    s_add_u32 s49, s6, 31232
    buffer_load_dwordx4 v[92:95], v3, s[32:35], s49 offen sc1
    s_add_u32 s49, s6, 1024
    buffer_load_dwordx4 v[96:99], v3, s[32:35], s49 offen sc1
    s_add_u32 s49, s6, 11264
    buffer_load_dwordx4 v[100:103], v3, s[32:35], s49 offen sc1
    s_add_u32 s49, s6, 21504
    buffer_load_dwordx4 v[104:107], v3, s[32:35], s49 offen sc1
    s_add_u32 s49, s6, 31744
    buffer_load_dwordx4 v[108:111], v3, s[32:35], s49 offen sc1
    s_mov_b32 s41, 0x00003f80
    s_mov_b32 s42, 0x3f800000
    s_waitcnt vmcnt(8)
    v_dot2_f32_bf16 v128, v64, s41, 0
    v_dot2_f32_bf16 v129, v64, s42, 0
    v_dot2_f32_bf16 v130, v65, s41, 0
    v_dot2_f32_bf16 v131, v65, s42, 0
    v_dot2_f32_bf16 v132, v66, s41, 0
    v_dot2_f32_bf16 v133, v66, s42, 0
    v_dot2_f32_bf16 v134, v67, s41, 0
    v_dot2_f32_bf16 v135, v67, s42, 0
    v_dot2_f32_bf16 v128, v68, s41, v128
    v_dot2_f32_bf16 v129, v68, s42, v129
    v_dot2_f32_bf16 v130, v69, s41, v130
    v_dot2_f32_bf16 v131, v69, s42, v131
    v_dot2_f32_bf16 v132, v70, s41, v132
    v_dot2_f32_bf16 v133, v70, s42, v133
    v_dot2_f32_bf16 v134, v71, s41, v134
    v_dot2_f32_bf16 v135, v71, s42, v135
    v_dot2_f32_bf16 v128, v72, s41, v128
    v_dot2_f32_bf16 v129, v72, s42, v129
    v_dot2_f32_bf16 v130, v73, s41, v130
    v_dot2_f32_bf16 v131, v73, s42, v131
    v_dot2_f32_bf16 v132, v74, s41, v132
    v_dot2_f32_bf16 v133, v74, s42, v133
    v_dot2_f32_bf16 v134, v75, s41, v134
    v_dot2_f32_bf16 v135, v75, s42, v135
    v_dot2_f32_bf16 v128, v76, s41, v128
    v_dot2_f32_bf16 v129, v76, s42, v129
    v_dot2_f32_bf16 v130, v77, s41, v130
    v_dot2_f32_bf16 v131, v77, s42, v131
    v_dot2_f32_bf16 v132, v78, s41, v132
    v_dot2_f32_bf16 v133, v78, s42, v133
    v_dot2_f32_bf16 v134, v79, s41, v134
    v_dot2_f32_bf16 v135, v79, s42, v135
    s_nop 3
    v_permlane32_swap_b32 v128, v132
    v_permlane32_swap_b32 v129, v133
    v_permlane32_swap_b32 v130, v134
    v_permlane32_swap_b32 v131, v135
    s_nop 1
    v_add_f32 v128, v128, v132
    v_add_f32 v129, v129, v133
    v_add_f32 v130, v130, v134
    v_add_f32 v131, v131, v135
    v_cvt_pk_bf16_f32 v128, v128, v129
    v_cvt_pk_bf16_f32 v129, v130, v131
    buffer_store_dwordx2 v[128:129], v4, s[28:31], s7 offen offset:0
    s_waitcnt vmcnt(5)
    v_dot2_f32_bf16 v136, v80, s41, 0
    v_dot2_f32_bf16 v137, v80, s42, 0
    v_dot2_f32_bf16 v138, v81, s41, 0
    v_dot2_f32_bf16 v139, v81, s42, 0
    v_dot2_f32_bf16 v140, v82, s41, 0
    v_dot2_f32_bf16 v141, v82, s42, 0
    v_dot2_f32_bf16 v142, v83, s41, 0
    v_dot2_f32_bf16 v143, v83, s42, 0
    v_dot2_f32_bf16 v136, v84, s41, v136
    v_dot2_f32_bf16 v137, v84, s42, v137
    v_dot2_f32_bf16 v138, v85, s41, v138
    v_dot2_f32_bf16 v139, v85, s42, v139
    v_dot2_f32_bf16 v140, v86, s41, v140
    v_dot2_f32_bf16 v141, v86, s42, v141
    v_dot2_f32_bf16 v142, v87, s41, v142
    v_dot2_f32_bf16 v143, v87, s42, v143
    v_dot2_f32_bf16 v136, v88, s41, v136
    v_dot2_f32_bf16 v137, v88, s42, v137
    v_dot2_f32_bf16 v138, v89, s41, v138
    v_dot2_f32_bf16 v139, v89, s42, v139
    v_dot2_f32_bf16 v140, v90, s41, v140
    v_dot2_f32_bf16 v141, v90, s42, v141
    v_dot2_f32_bf16 v142, v91, s41, v142
    v_dot2_f32_bf16 v143, v91, s42, v143
    v_dot2_f32_bf16 v136, v92, s41, v136
    v_dot2_f32_bf16 v137, v92, s42, v137
    v_dot2_f32_bf16 v138, v93, s41, v138
    v_dot2_f32_bf16 v139, v93, s42, v139
    v_dot2_f32_bf16 v140, v94, s41, v140
    v_dot2_f32_bf16 v141, v94, s42, v141
    v_dot2_f32_bf16 v142, v95, s41, v142
    v_dot2_f32_bf16 v143, v95, s42, v143
    s_nop 3
    v_permlane32_swap_b32 v136, v140
    v_permlane32_swap_b32 v137, v141
    v_permlane32_swap_b32 v138, v142
    v_permlane32_swap_b32 v139, v143
    s_nop 1
    v_add_f32 v136, v136, v140
    v_add_f32 v137, v137, v141
    v_add_f32 v138, v138, v142
    v_add_f32 v139, v139, v143
    v_cvt_pk_bf16_f32 v136, v136, v137
    v_cvt_pk_bf16_f32 v137, v138, v139
    buffer_store_dwordx2 v[136:137], v4, s[28:31], s7 offen offset:32
    s_waitcnt vmcnt(2)
    v_dot2_f32_bf16 v144, v96, s41, 0
    v_dot2_f32_bf16 v145, v96, s42, 0
    v_dot2_f32_bf16 v146, v97, s41, 0
    v_dot2_f32_bf16 v147, v97, s42, 0
    v_dot2_f32_bf16 v148, v98, s41, 0
    v_dot2_f32_bf16 v149, v98, s42, 0
    v_dot2_f32_bf16 v150, v99, s41, 0
    v_dot2_f32_bf16 v151, v99, s42, 0
    v_dot2_f32_bf16 v144, v100, s41, v144
    v_dot2_f32_bf16 v145, v100, s42, v145
    v_dot2_f32_bf16 v146, v101, s41, v146
    v_dot2_f32_bf16 v147, v101, s42, v147
    v_dot2_f32_bf16 v148, v102, s41, v148
    v_dot2_f32_bf16 v149, v102, s42, v149
    v_dot2_f32_bf16 v150, v103, s41, v150
    v_dot2_f32_bf16 v151, v103, s42, v151
    v_dot2_f32_bf16 v144, v104, s41, v144
    v_dot2_f32_bf16 v145, v104, s42, v145
    v_dot2_f32_bf16 v146, v105, s41, v146
    v_dot2_f32_bf16 v147, v105, s42, v147
    v_dot2_f32_bf16 v148, v106, s41, v148
    v_dot2_f32_bf16 v149, v106, s42, v149
    v_dot2_f32_bf16 v150, v107, s41, v150
    v_dot2_f32_bf16 v151, v107, s42, v151
    v_dot2_f32_bf16 v144, v108, s41, v144
    v_dot2_f32_bf16 v145, v108, s42, v145
    v_dot2_f32_bf16 v146, v109, s41, v146
    v_dot2_f32_bf16 v147, v109, s42, v147
    v_dot2_f32_bf16 v148, v110, s41, v148
    v_dot2_f32_bf16 v149, v110, s42, v149
    v_dot2_f32_bf16 v150, v111, s41, v150
    v_dot2_f32_bf16 v151, v111, s42, v151
    s_nop 3
    v_permlane32_swap_b32 v144, v148
    v_permlane32_swap_b32 v145, v149
    v_permlane32_swap_b32 v146, v150
    v_permlane32_swap_b32 v147, v151
    s_nop 1
    v_add_f32 v144, v144, v148
    v_add_f32 v145, v145, v149
    v_add_f32 v146, v146, v150
    v_add_f32 v147, v147, v151
    v_cvt_pk_bf16_f32 v144, v144, v145
    v_cvt_pk_bf16_f32 v145, v146, v147
    buffer_store_dwordx2 v[144:145], v4, s[28:31], s7 offen offset:64
    s_branch L_p3_done
L_p3_two:
    s_add_u32 s49, s6, 0
    buffer_load_dwordx4 v[64:67], v3, s[32:35], s49 offen sc1
    s_add_u32 s49, s6, 10240
    buffer_load_dwordx4 v[68:71], v3, s[32:35], s49 offen sc1
    s_add_u32 s49, s6, 20480
    buffer_load_dwordx4 v[72:75], v3, s[32:35], s49 offen sc1
    s_add_u32 s49, s6, 30720
    buffer_load_dwordx4 v[76:79], v3, s[32:35], s49 offen sc1
    s_add_u32 s49, s6, 512
    buffer_load_dwordx4 v[80:83], v3, s[32:35], s49 offen sc1
    s_add_u32 s49, s6, 10752
    buffer_load_dwordx4 v[84:87], v3, s[32:35], s49 offen sc1
    s_add_u32 s49, s6, 20992
    buffer_load_dwordx4 v[88:91], v3, s[32:35], s49 offen sc1
    s_add_u32 s49, s6, 31232
    buffer_load_dwordx4 v[92:95], v3, s[32:35], s49 offen sc1
    s_mov_b32 s41, 0x00003f80
    s_mov_b32 s42, 0x3f800000
    s_waitcnt vmcnt(4)
    v_dot2_f32_bf16 v128, v64, s41, 0
    v_dot2_f32_bf16 v129, v64, s42, 0
    v_dot2_f32_bf16 v130, v65, s41, 0
    v_dot2_f32_bf16 v131, v65, s42, 0
    v_dot2_f32_bf16 v132, v66, s41, 0
    v_dot2_f32_bf16 v133, v66, s42, 0
    v_dot2_f32_bf16 v134, v67, s41, 0
    v_dot2_f32_bf16 v135, v67, s42, 0
    v_dot2_f32_bf16 v128, v68, s41, v128
    v_dot2_f32_bf16 v129, v68, s42, v129
    v_dot2_f32_bf16 v130, v69, s41, v130
    v_dot2_f32_bf16 v131, v69, s42, v131
    v_dot2_f32_bf16 v132, v70, s41, v132
    v_dot2_f32_bf16 v133, v70, s42, v133
    v_dot2_f32_bf16 v134, v71, s41, v134
    v_dot2_f32_bf16 v135, v71, s42, v135
    v_dot2_f32_bf16 v128, v72, s41, v128
    v_dot2_f32_bf16 v129, v72, s42, v129
    v_dot2_f32_bf16 v130, v73, s41, v130
    v_dot2_f32_bf16 v131, v73, s42, v131
    v_dot2_f32_bf16 v132, v74, s41, v132
    v_dot2_f32_bf16 v133, v74, s42, v133
    v_dot2_f32_bf16 v134, v75, s41, v134
    v_dot2_f32_bf16 v135, v75, s42, v135
    v_dot2_f32_bf16 v128, v76, s41, v128
    v_dot2_f32_bf16 v129, v76, s42, v129
    v_dot2_f32_bf16 v130, v77, s41, v130
    v_dot2_f32_bf16 v131, v77, s42, v131
    v_dot2_f32_bf16 v132, v78, s41, v132
    v_dot2_f32_bf16 v133, v78, s42, v133
    v_dot2_f32_bf16 v134, v79, s41, v134
    v_dot2_f32_bf16 v135, v79, s42, v135
    s_nop 3
    v_permlane32_swap_b32 v128, v132
    v_permlane32_swap_b32 v129, v133
    v_permlane32_swap_b32 v130, v134
    v_permlane32_swap_b32 v131, v135
    s_nop 1
    v_add_f32 v128, v128, v132
    v_add_f32 v129, v129, v133
    v_add_f32 v130, v130, v134
    v_add_f32 v131, v131, v135
    v_cvt_pk_bf16_f32 v128, v128, v129
    v_cvt_pk_bf16_f32 v129, v130, v131
    buffer_store_dwordx2 v[128:129], v4, s[28:31], s7 offen offset:0
    s_waitcnt vmcnt(1)
    v_dot2_f32_bf16 v136, v80, s41, 0
    v_dot2_f32_bf16 v137, v80, s42, 0
    v_dot2_f32_bf16 v138, v81, s41, 0
    v_dot2_f32_bf16 v139, v81, s42, 0
    v_dot2_f32_bf16 v140, v82, s41, 0
    v_dot2_f32_bf16 v141, v82, s42, 0
    v_dot2_f32_bf16 v142, v83, s41, 0
    v_dot2_f32_bf16 v143, v83, s42, 0
    v_dot2_f32_bf16 v136, v84, s41, v136
    v_dot2_f32_bf16 v137, v84, s42, v137
    v_dot2_f32_bf16 v138, v85, s41, v138
    v_dot2_f32_bf16 v139, v85, s42, v139
    v_dot2_f32_bf16 v140, v86, s41, v140
    v_dot2_f32_bf16 v141, v86, s42, v141
    v_dot2_f32_bf16 v142, v87, s41, v142
    v_dot2_f32_bf16 v143, v87, s42, v143
    v_dot2_f32_bf16 v136, v88, s41, v136
    v_dot2_f32_bf16 v137, v88, s42, v137
    v_dot2_f32_bf16 v138, v89, s41, v138
    v_dot2_f32_bf16 v139, v89, s42, v139
    v_dot2_f32_bf16 v140, v90, s41, v140
    v_dot2_f32_bf16 v141, v90, s42, v141
    v_dot2_f32_bf16 v142, v91, s41, v142
    v_dot2_f32_bf16 v143, v91, s42, v143
    v_dot2_f32_bf16 v136, v92, s41, v136
    v_dot2_f32_bf16 v137, v92, s42, v137
    v_dot2_f32_bf16 v138, v93, s41, v138
    v_dot2_f32_bf16 v139, v93, s42, v139
    v_dot2_f32_bf16 v140, v94, s41, v140
    v_dot2_f32_bf16 v141, v94, s42, v141
    v_dot2_f32_bf16 v142, v95, s41, v142
    v_dot2_f32_bf16 v143, v95, s42, v143
    s_nop 3
    v_permlane32_swap_b32 v136, v140
    v_permlane32_swap_b32 v137, v141
    v_permlane32_swap_b32 v138, v142
    v_permlane32_swap_b32 v139, v143
    s_nop 1
    v_add_f32 v136, v136, v140
    v_add_f32 v137, v137, v141
    v_add_f32 v138, v138, v142
    v_add_f32 v139, v139, v143
    v_cvt_pk_bf16_f32 v136, v136, v137
    v_cvt_pk_bf16_f32 v137, v138, v139
    buffer_store_dwordx2 v[136:137], v4, s[28:31], s7 offen offset:32
L_p3_done:
    s_or_b32 s43, s37, s36
    s_cmp_lg_u32 s43, 0
    s_cbranch_scc1 L_noe2
    s_lshl_b32 s43, s59, 4
    s_add_u32 s43, s43, 0x2002000
    v_mov_b32 v8, s43
    s_mov_b64 exec, 1
    buffer_store_dword v7, v8, s[32:35], 0 offen sc1
    s_mov_b64 exec, -1
L_noe2:
L_end:
    s_endpgm
.section .rodata,"a"
.p2align 6
.amdhsa_kernel standalone__gqa_block_cached__near_ridge_kernel
  .amdhsa_next_free_vgpr 256
  .amdhsa_next_free_sgpr 100
  .amdhsa_accum_offset 256
  .amdhsa_group_segment_fixed_size 0
  .amdhsa_kernarg_size 64
  .amdhsa_user_sgpr_count 2
  .amdhsa_user_sgpr_kernarg_segment_ptr 1
  .amdhsa_system_sgpr_workgroup_id_x 1
.end_amdhsa_kernel
```
